```python
import torch

def _softmax(x, axis=-1):
    return torch.softmax(x, dim=axis)
def _gelu(x):
    return torch.nn.functional.gelu(x, approximate="tanh")
def _silu(x):
    return torch.nn.functional.silu(x)
def _sigmoid(x):
    return torch.sigmoid(x)
def _layernorm(x, axis=-1, eps=1e-5):
    m = x.mean(dim=axis, keepdim=True)
    v = x.var(dim=axis, keepdim=True, unbiased=False)
    return (x - m) / torch.sqrt(v + eps)
def _scatter_add(tgt, idx, src, axis=0):
    return tgt.clone().index_add_(axis, idx, src)
def _segment_sum(src, seg, n):
    out = torch.zeros((n,) + src.shape[1:], dtype=src.dtype)
    return out.index_add_(0, seg, src)
def _pad(x, pw):
    flat = tuple(v for pair in reversed(pw) for v in pair)
    return torch.nn.functional.pad(x, flat)

kernel_name = 'concat_heads__gqa_block_cached__mha_block_cached__decode'

def setup_inputs():

    _w = (lambda a: (lambda t: t.to(torch.bfloat16) if t.is_floating_point() else t)(torch.as_tensor(a)))
    def _A_setup():
        B, Sq, D = 4, 1, 448
        Hq, Hkv, Sk, Dh = 16, 8, 16384, 256
        assert Hq % Hkv == 0, (Hq, Hkv)
        return {
            "x": _w((lambda *s: torch.randn(*s, dtype=torch.bfloat16) * 0.8)(B, Sq, D)),
            "k_cache": _w((lambda *s: torch.randn(*s, dtype=torch.bfloat16) * 0.8)(B, Hkv, Sk, Dh)),
            "v_cache": _w((lambda *s: torch.randn(*s, dtype=torch.bfloat16) * 0.05)(B, Hkv, Sk, Dh)),
            "wq": _w((lambda *s: torch.randn(*s, dtype=torch.bfloat16) * 0.8)(D, Hq * Dh) * (D ** -0.5)),
            "wo": _w((lambda *s: torch.randn(*s, dtype=torch.bfloat16) * 0.05)(Hq * Dh, D) * ((Hq * Dh) ** -0.5)),
        }
    _A_in = _A_setup()

    def _B_setup():
        B, Sq, D = 4, 1, 448
        H, Sk, Dh = 16, 16384, 256
        return {
            "x": _w((lambda *s: torch.randn(*s, dtype=torch.bfloat16) * 0.8)(B, Sq, D)),
            "k_cache": _w((lambda *s: torch.randn(*s, dtype=torch.bfloat16) * 0.8)(B, H, Sk, Dh)),
            "v_cache": _w((lambda *s: torch.randn(*s, dtype=torch.bfloat16) * 0.05)(B, H, Sk, Dh)),
            "wq": _w((lambda *s: torch.randn(*s, dtype=torch.bfloat16) * 0.8)(D, H * Dh) * (D ** -0.5)),
            "wo": _w((lambda *s: torch.randn(*s, dtype=torch.bfloat16) * 0.05)(H * Dh, D) * ((H * Dh) ** -0.5)),
        }
    _B_in = _B_setup()

    return {
        "A_x": _A_in["x"],
        "A_k_cache": _A_in["k_cache"],
        "A_v_cache": _A_in["v_cache"],
        "A_wq": _A_in["wq"],
        "A_wo": _A_in["wo"],
        "B_x": _B_in["x"],
        "B_k_cache": _B_in["k_cache"],
        "B_v_cache": _B_in["v_cache"],
        "B_wq": _B_in["wq"],
        "B_wo": _B_in["wo"],
    }

def reference(A_x, A_k_cache, A_v_cache, A_wq, A_wo, B_x, B_k_cache, B_v_cache, B_wq, B_wo):
    def _A_ref(x, k_cache, v_cache, wq, wo):
        B, Sq, D = x.shape
        Hq, Dh = 16, 256
        Hkv = k_cache.shape[1]
        rep = Hq // Hkv
        q = (lambda x, *d: x.permute(*d))((x @ wq).reshape(B, Sq, Hq, Dh), 0, 2, 1, 3)
        k = (lambda x, n, axis: torch.repeat_interleave(x, n, dim=axis))(k_cache, rep, axis=1)
        v = (lambda x, n, axis: torch.repeat_interleave(x, n, dim=axis))(v_cache, rep, axis=1)
        scores = torch.einsum("bhqd,bhkd->bhqk", q, k) * (Dh ** -0.5)
        p = _softmax(scores, axis=-1)
        o = torch.einsum("bhqk,bhkd->bhqd", p, v)
        return (lambda x, *d: x.permute(*d))(o, 0, 2, 1, 3).reshape(B, Sq, Hq * Dh) @ wo

    def _B_ref(x, k_cache, v_cache, wq, wo):
        B, Sq, D = x.shape
        H, Dh = 16, 256
        q = (lambda x, *d: x.permute(*d))((x @ wq).reshape(B, Sq, H, Dh), 0, 2, 1, 3)
        scores = torch.einsum("bhqd,bhkd->bhqk", q, k_cache) * (Dh ** -0.5)
        p = _softmax(scores, axis=-1)
        o = torch.einsum("bhqk,bhkd->bhqd", p, v_cache)
        return (lambda x, *d: x.permute(*d))(o, 0, 2, 1, 3).reshape(B, Sq, H * Dh) @ wo

    a = _A_ref(A_x, A_k_cache, A_v_cache, A_wq, A_wo)
    b = _B_ref(B_x, B_k_cache, B_v_cache, B_wq, B_wo)
    return torch.concatenate([a, b], axis=-1)
```

```asm
; @launch grid=(256,1,1) block=(320,1,1) lds=163840
.amdgcn_target "amdgcn-amd-amdhsa--gfx950"
.text
.globl concat_heads__gqa_block_cached__mha_block_cached__decode_kernel
.p2align 8
.type concat_heads__gqa_block_cached__mha_block_cached__decode_kernel,@function
concat_heads__gqa_block_cached__mha_block_cached__decode_kernel:
s_cmp_ge_u32 s2, 256
s_cbranch_scc1 L_end
s_load_dwordx16 s[4:19], s[0:1], 0
s_load_dwordx8 s[20:27], s[0:1], 64
s_load_dwordx2 s[28:29], s[0:1], 96
v_lshrrev_b32 v1, 6, v0
v_and_b32 v0, 63, v0
v_readfirstlane_b32 s3, v1
s_and_b32 s30, s2, 7
s_lshr_b32 s31, s2, 3
s_mul_i32 s34, s30, 27
s_add_u32 s31, s31, s34
s_and_b32 s31, s31, 31
s_lshl_b32 s2, s31, 3
s_or_b32 s2, s2, s30
s_and_b32 s32, s31, 7
s_lshr_b32 s33, s31, 3
s_lshr_b32 s35, s33, 1
s_and_b32 s34, s33, 1
s_lshl_b32 s36, s30, 1
s_add_u32 s36, s36, s34
s_lshl_b32 s34, s35, 4
s_add_u32 s34, s34, s36
s_cmp_eq_u32 s3, 4
s_cbranch_scc1 L_service
s_lshl_b32 s47, s3, 15
s_mul_i32 s44, s31, 1
s_xor_b32 s44, s44, s30
s_and_b32 s44, s44, 7
s_lshl_b32 s44, s44, 14
s_lshl_b32 s45, s3, 12
s_add_u32 s44, s44, s45
s_mov_b32 s69, 0
s_mov_b32 s60, 0x3db8aa3b
s_mov_b32 s61, 0xbdb8aa3b
v_lshrrev_b32 v22, 5, v0
v_and_b32 v23, 31, v0
v_add_u32 v24, 0, v22
v_and_b32 v24, 7, v24
v_lshlrev_b32 v24, 1, v24
v_xor_b32 v24, v24, v23
v_lshlrev_b32 v24, 4, v24
v_lshl_add_u32 v2, v22, 9, v24
v_add_u32 v24, 2, v22
v_and_b32 v24, 7, v24
v_lshlrev_b32 v24, 1, v24
v_xor_b32 v24, v24, v23
v_lshlrev_b32 v24, 4, v24
v_lshl_add_u32 v3, v22, 9, v24
v_add_u32 v24, 4, v22
v_and_b32 v24, 7, v24
v_lshlrev_b32 v24, 1, v24
v_xor_b32 v24, v24, v23
v_lshlrev_b32 v24, 4, v24
v_lshl_add_u32 v4, v22, 9, v24
v_add_u32 v24, 6, v22
v_and_b32 v24, 7, v24
v_lshlrev_b32 v24, 1, v24
v_xor_b32 v24, v24, v23
v_lshlrev_b32 v24, 4, v24
v_lshl_add_u32 v5, v22, 9, v24
s_waitcnt lgkmcnt(0)
s_lshl_b32 s62, s33, 3
s_add_u32 s62, s62, s32
s_lshl_b32 s63, s62, 23
s_lshr_b32 s64, s62, 9
s_add_u32 s48, s6, s63
s_addc_u32 s49, s7, s64
s_add_u32 s50, s8, s63
s_addc_u32 s51, s9, s64
s_lshr_b32 s62, s33, 1
s_lshl_b32 s62, s62, 4
s_lshl_b32 s65, s32, 1
s_add_u32 s62, s62, s65
s_and_b32 s65, s33, 1
s_add_u32 s62, s62, s65
s_lshl_b32 s63, s62, 23
s_lshr_b32 s64, s62, 9
s_add_u32 s52, s16, s63
s_addc_u32 s53, s17, s64
s_add_u32 s54, s18, s63
s_addc_u32 s55, s19, s64
s_mov_b32 s36, s48
s_mov_b32 s37, s49
s_mov_b32 s38, 0x800000
s_mov_b32 s39, 0x20000
s_mov_b32 s43, 0x20000
s_lshl_b32 s57, s3, 12
s_add_u32 s57, s57, 147456
s_mov_b32 s45, 0
s_brev_b32 s45, s45
s_lshr_b32 s45, s45, 28
s_lshl_b32 s45, s45, 17
s_add_u32 s45, s45, s44
s_add_u32 m0, s47, 0
s_add_u32 s46, s45, 0
buffer_load_dwordx4 v2, s[36:39], s46 offen offset:0 sc0 sc1 nt lds
v_and_b32 v21, 15, v0
v_lshrrev_b32 v22, 4, v0
v_and_b32 v23, 7, v0
v_lshlrev_b32 v23, 1, v23
v_add_u32 v24, 0, v22
v_xor_b32 v24, v24, v23
v_lshlrev_b32 v24, 4, v24
v_lshl_add_u32 v24, v21, 9, v24
v_add_u32 v6, s47, v24
v_add_u32 v24, 4, v22
v_xor_b32 v24, v24, v23
v_lshlrev_b32 v24, 4, v24
v_lshl_add_u32 v24, v21, 9, v24
v_add_u32 v7, s47, v24
v_add_u32 v24, 8, v22
v_xor_b32 v24, v24, v23
v_lshlrev_b32 v24, 4, v24
v_lshl_add_u32 v24, v21, 9, v24
v_add_u32 v8, s47, v24
v_add_u32 v24, 12, v22
v_xor_b32 v24, v24, v23
v_lshlrev_b32 v24, 4, v24
v_lshl_add_u32 v24, v21, 9, v24
v_add_u32 v9, s47, v24
v_lshrrev_b32 v24, 2, v21
v_lshl_add_u32 v24, v22, 2, v24
v_and_b32 v25, 7, v24
v_lshlrev_b32 v25, 1, v25
v_lshlrev_b32 v24, 9, v24
v_and_b32 v26, 3, v21
v_lshl_add_u32 v24, v26, 3, v24
v_add_u32 v24, s47, v24
v_xor_b32 v26, 0, v25
v_lshl_add_u32 v10, v26, 4, v24
v_xor_b32 v26, 2, v25
v_lshl_add_u32 v11, v26, 4, v24
v_xor_b32 v26, 4, v25
v_lshl_add_u32 v12, v26, 4, v24
v_xor_b32 v26, 6, v25
v_lshl_add_u32 v13, v26, 4, v24
v_xor_b32 v26, 8, v25
v_lshl_add_u32 v14, v26, 4, v24
v_xor_b32 v26, 10, v25
v_lshl_add_u32 v15, v26, 4, v24
v_xor_b32 v26, 12, v25
v_lshl_add_u32 v16, v26, 4, v24
v_xor_b32 v26, 14, v25
v_lshl_add_u32 v17, v26, 4, v24
v_mov_b32 v18, 0xff7fffff
v_mov_b32 v19, 0
v_mul_f32 v20, s61, v18
buffer_load_dwordx4 v3, s[36:39], s46 offen offset:1024 sc0 sc1 nt lds
buffer_load_dwordx4 v4, s[36:39], s46 offen offset:2048 sc0 sc1 nt lds
buffer_load_dwordx4 v5, s[36:39], s46 offen offset:3072 sc0 sc1 nt lds
s_add_u32 m0, s47, 4096
s_add_u32 s46, s45, 2097152
buffer_load_dwordx4 v2, s[36:39], s46 offen offset:0 sc0 sc1 nt lds
buffer_load_dwordx4 v3, s[36:39], s46 offen offset:1024 sc0 sc1 nt lds
buffer_load_dwordx4 v4, s[36:39], s46 offen offset:2048 sc0 sc1 nt lds
buffer_load_dwordx4 v5, s[36:39], s46 offen offset:3072 sc0 sc1 nt lds
s_waitcnt vmcnt(7)
s_add_u32 m0, s47, 8192
s_add_u32 s46, s45, 4194304
buffer_load_dwordx4 v2, s[36:39], s46 offen offset:0 sc0 sc1 nt lds
s_waitcnt vmcnt(7)
buffer_load_dwordx4 v3, s[36:39], s46 offen offset:1024 sc0 sc1 nt lds
s_waitcnt vmcnt(7)
buffer_load_dwordx4 v4, s[36:39], s46 offen offset:2048 sc0 sc1 nt lds
s_waitcnt vmcnt(7)
buffer_load_dwordx4 v5, s[36:39], s46 offen offset:3072 sc0 sc1 nt lds
s_waitcnt vmcnt(7)
s_add_u32 m0, s47, 12288
s_add_u32 s46, s45, 6291456
buffer_load_dwordx4 v2, s[36:39], s46 offen offset:0 sc0 sc1 nt lds
s_waitcnt vmcnt(7)
buffer_load_dwordx4 v3, s[36:39], s46 offen offset:1024 sc0 sc1 nt lds
s_waitcnt vmcnt(7)
buffer_load_dwordx4 v4, s[36:39], s46 offen offset:2048 sc0 sc1 nt lds
s_waitcnt vmcnt(7)
buffer_load_dwordx4 v5, s[36:39], s46 offen offset:3072 sc0 sc1 nt lds
s_mov_b32 s45, 1
s_brev_b32 s45, s45
s_lshr_b32 s45, s45, 28
s_lshl_b32 s45, s45, 17
s_add_u32 s45, s45, s44
s_waitcnt vmcnt(4)
s_add_u32 m0, s47, 16384
s_add_u32 s46, s45, 0
buffer_load_dwordx4 v2, s[36:39], s46 offen offset:0 sc0 sc1 nt lds
s_waitcnt vmcnt(4)
buffer_load_dwordx4 v3, s[36:39], s46 offen offset:1024 sc0 sc1 nt lds
s_waitcnt vmcnt(4)
buffer_load_dwordx4 v4, s[36:39], s46 offen offset:2048 sc0 sc1 nt lds
s_waitcnt vmcnt(4)
buffer_load_dwordx4 v5, s[36:39], s46 offen offset:3072 sc0 sc1 nt lds
s_waitcnt vmcnt(4)
s_add_u32 m0, s47, 20480
s_add_u32 s46, s45, 2097152
buffer_load_dwordx4 v2, s[36:39], s46 offen offset:0 sc0 sc1 nt lds
ds_read_b128 v[96:99], v6 offset:0
ds_read_b128 v[100:103], v7 offset:0
ds_read_b128 v[104:107], v8 offset:0
ds_read_b128 v[108:111], v9 offset:0
ds_read_b128 v[112:115], v6 offset:256
ds_read_b128 v[116:119], v7 offset:256
ds_read_b128 v[120:123], v8 offset:256
ds_read_b128 v[124:127], v9 offset:256
ds_read_b128 v[128:131], v6 offset:8192
ds_read_b128 v[132:135], v7 offset:8192
ds_read_b128 v[136:139], v8 offset:8192
ds_read_b128 v[140:143], v9 offset:8192
ds_read_b128 v[144:147], v6 offset:8448
ds_read_b128 v[148:151], v7 offset:8448
ds_read_b128 v[152:155], v8 offset:8448
ds_read_b128 v[156:159], v9 offset:8448
s_waitcnt vmcnt(4)
buffer_load_dwordx4 v3, s[36:39], s46 offen offset:1024 sc0 sc1 nt lds
s_waitcnt vmcnt(4)
buffer_load_dwordx4 v4, s[36:39], s46 offen offset:2048 sc0 sc1 nt lds
s_waitcnt vmcnt(4)
buffer_load_dwordx4 v5, s[36:39], s46 offen offset:3072 sc0 sc1 nt lds
s_waitcnt vmcnt(4)
s_add_u32 m0, s47, 24576
s_add_u32 s46, s45, 4194304
buffer_load_dwordx4 v2, s[36:39], s46 offen offset:0 sc0 sc1 nt lds
s_waitcnt vmcnt(4)
buffer_load_dwordx4 v3, s[36:39], s46 offen offset:1024 sc0 sc1 nt lds
s_waitcnt vmcnt(4)
buffer_load_dwordx4 v4, s[36:39], s46 offen offset:2048 sc0 sc1 nt lds
s_waitcnt vmcnt(4)
buffer_load_dwordx4 v5, s[36:39], s46 offen offset:3072 sc0 sc1 nt lds
s_waitcnt vmcnt(4)
s_add_u32 m0, s47, 28672
s_add_u32 s46, s45, 6291456
buffer_load_dwordx4 v2, s[36:39], s46 offen offset:0 sc0 sc1 nt lds
s_waitcnt vmcnt(4)
buffer_load_dwordx4 v3, s[36:39], s46 offen offset:1024 sc0 sc1 nt lds
s_waitcnt vmcnt(4)
buffer_load_dwordx4 v4, s[36:39], s46 offen offset:2048 sc0 sc1 nt lds
s_waitcnt vmcnt(4)
buffer_load_dwordx4 v5, s[36:39], s46 offen offset:3072 sc0 sc1 nt lds
s_waitcnt lgkmcnt(0)
s_mov_b32 s45, 2
s_brev_b32 s45, s45
s_lshr_b32 s45, s45, 28
s_lshl_b32 s45, s45, 17
s_add_u32 s45, s45, s44
s_waitcnt vmcnt(4)
s_add_u32 m0, s47, 0
s_add_u32 s46, s45, 0
buffer_load_dwordx4 v2, s[36:39], s46 offen offset:0 sc0 sc1 nt lds
s_waitcnt vmcnt(4)
buffer_load_dwordx4 v3, s[36:39], s46 offen offset:1024 sc0 sc1 nt lds
s_waitcnt vmcnt(4)
buffer_load_dwordx4 v4, s[36:39], s46 offen offset:2048 sc0 sc1 nt lds
s_waitcnt vmcnt(4)
buffer_load_dwordx4 v5, s[36:39], s46 offen offset:3072 sc0 sc1 nt lds
s_waitcnt vmcnt(4)
s_add_u32 m0, s47, 4096
s_add_u32 s46, s45, 2097152
buffer_load_dwordx4 v2, s[36:39], s46 offen offset:0 sc0 sc1 nt lds
ds_read_b128 v[160:163], v6 offset:16384
ds_read_b128 v[164:167], v7 offset:16384
ds_read_b128 v[168:171], v8 offset:16384
ds_read_b128 v[172:175], v9 offset:16384
ds_read_b128 v[176:179], v6 offset:16640
ds_read_b128 v[180:183], v7 offset:16640
ds_read_b128 v[184:187], v8 offset:16640
ds_read_b128 v[188:191], v9 offset:16640
ds_read_b128 v[192:195], v6 offset:24576
ds_read_b128 v[196:199], v7 offset:24576
ds_read_b128 v[200:203], v8 offset:24576
ds_read_b128 v[204:207], v9 offset:24576
ds_read_b128 v[208:211], v6 offset:24832
ds_read_b128 v[212:215], v7 offset:24832
ds_read_b128 v[216:219], v8 offset:24832
ds_read_b128 v[220:223], v9 offset:24832
s_waitcnt vmcnt(4)
buffer_load_dwordx4 v3, s[36:39], s46 offen offset:1024 sc0 sc1 nt lds
s_waitcnt vmcnt(4)
buffer_load_dwordx4 v4, s[36:39], s46 offen offset:2048 sc0 sc1 nt lds
s_waitcnt vmcnt(4)
buffer_load_dwordx4 v5, s[36:39], s46 offen offset:3072 sc0 sc1 nt lds
s_waitcnt vmcnt(4)
s_add_u32 m0, s47, 8192
s_add_u32 s46, s45, 4194304
buffer_load_dwordx4 v2, s[36:39], s46 offen offset:0 sc0 sc1 nt lds
s_waitcnt vmcnt(4)
buffer_load_dwordx4 v3, s[36:39], s46 offen offset:1024 sc0 sc1 nt lds
s_waitcnt vmcnt(4)
buffer_load_dwordx4 v4, s[36:39], s46 offen offset:2048 sc0 sc1 nt lds
s_waitcnt vmcnt(4)
buffer_load_dwordx4 v5, s[36:39], s46 offen offset:3072 sc0 sc1 nt lds
s_waitcnt vmcnt(4)
s_add_u32 m0, s47, 12288
s_add_u32 s46, s45, 6291456
buffer_load_dwordx4 v2, s[36:39], s46 offen offset:0 sc0 sc1 nt lds
s_waitcnt vmcnt(4)
buffer_load_dwordx4 v3, s[36:39], s46 offen offset:1024 sc0 sc1 nt lds
s_waitcnt vmcnt(4)
buffer_load_dwordx4 v4, s[36:39], s46 offen offset:2048 sc0 sc1 nt lds
s_waitcnt vmcnt(4)
buffer_load_dwordx4 v5, s[36:39], s46 offen offset:3072 sc0 sc1 nt lds
s_waitcnt lgkmcnt(0)
s_mov_b32 s45, 3
s_brev_b32 s45, s45
s_lshr_b32 s45, s45, 28
s_lshl_b32 s45, s45, 17
s_add_u32 s45, s45, s44
s_waitcnt vmcnt(4)
s_add_u32 m0, s47, 16384
s_add_u32 s46, s45, 0
buffer_load_dwordx4 v2, s[36:39], s46 offen offset:0 sc0 sc1 nt lds
s_waitcnt vmcnt(4)
buffer_load_dwordx4 v3, s[36:39], s46 offen offset:1024 sc0 sc1 nt lds
s_waitcnt vmcnt(4)
buffer_load_dwordx4 v4, s[36:39], s46 offen offset:2048 sc0 sc1 nt lds
s_waitcnt vmcnt(4)
buffer_load_dwordx4 v5, s[36:39], s46 offen offset:3072 sc0 sc1 nt lds
s_waitcnt vmcnt(4)
s_add_u32 m0, s47, 20480
s_add_u32 s46, s45, 2097152
buffer_load_dwordx4 v2, s[36:39], s46 offen offset:0 sc0 sc1 nt lds
s_waitcnt vmcnt(4)
buffer_load_dwordx4 v3, s[36:39], s46 offen offset:1024 sc0 sc1 nt lds
s_waitcnt vmcnt(4)
buffer_load_dwordx4 v4, s[36:39], s46 offen offset:2048 sc0 sc1 nt lds
s_waitcnt vmcnt(4)
buffer_load_dwordx4 v5, s[36:39], s46 offen offset:3072 sc0 sc1 nt lds
s_waitcnt vmcnt(4)
s_add_u32 m0, s47, 24576
s_add_u32 s46, s45, 4194304
buffer_load_dwordx4 v2, s[36:39], s46 offen offset:0 sc0 sc1 nt lds
s_waitcnt vmcnt(4)
buffer_load_dwordx4 v3, s[36:39], s46 offen offset:1024 sc0 sc1 nt lds
s_waitcnt vmcnt(4)
buffer_load_dwordx4 v4, s[36:39], s46 offen offset:2048 sc0 sc1 nt lds
s_waitcnt vmcnt(4)
buffer_load_dwordx4 v5, s[36:39], s46 offen offset:3072 sc0 sc1 nt lds
s_waitcnt vmcnt(4)
s_add_u32 m0, s47, 28672
s_add_u32 s46, s45, 6291456
buffer_load_dwordx4 v2, s[36:39], s46 offen offset:0 sc0 sc1 nt lds
s_waitcnt vmcnt(4)
buffer_load_dwordx4 v3, s[36:39], s46 offen offset:1024 sc0 sc1 nt lds
s_waitcnt vmcnt(4)
buffer_load_dwordx4 v4, s[36:39], s46 offen offset:2048 sc0 sc1 nt lds
s_waitcnt vmcnt(4)
buffer_load_dwordx4 v5, s[36:39], s46 offen offset:3072 sc0 sc1 nt lds
s_barrier
v_and_b32 v22, 3, v0
v_lshrrev_b32 v23, 4, v0
v_lshlrev_b32 v22, 9, v22
v_lshl_add_u32 v22, v23, 4, v22
v_add_u32 v22, 131072, v22
ds_read_b128 v[64:67], v22 offset:0
ds_read_b128 v[68:71], v22 offset:64
ds_read_b128 v[72:75], v22 offset:128
ds_read_b128 v[76:79], v22 offset:192
ds_read_b128 v[80:83], v22 offset:256
ds_read_b128 v[84:87], v22 offset:320
ds_read_b128 v[88:91], v22 offset:384
ds_read_b128 v[92:95], v22 offset:448
v_cmp_gt_u32 vcc, 2, v21
v_mov_b32 v22, 0xff800000
v_mov_b32 v23, 0
v_cndmask_b32 v28, v22, v23, vcc
v_cndmask_b32 v29, v22, v23, vcc
v_cndmask_b32 v30, v22, v23, vcc
v_cndmask_b32 v31, v22, v23, vcc
s_mov_b32 s58, 0x00030003
s_mov_b32 s59, 0x00030003
v_lshrrev_b32 v22, 4, v0
v_lshlrev_b32 v22, 6, v22
v_and_b32 v23, 1, v0
v_lshl_add_u32 v22, v23, 5, v22
v_add_u32 v55, s57, v22
s_waitcnt lgkmcnt(0)
v_mfma_f32_16x16x32_bf16 v[32:35], v[96:99], v[64:67], v[28:31]
v_mfma_f32_16x16x32_bf16 v[32:35], v[100:103], v[68:71], v[32:35]
v_mfma_f32_16x16x32_bf16 v[32:35], v[104:107], v[72:75], v[32:35]
v_mfma_f32_16x16x32_bf16 v[32:35], v[108:111], v[76:79], v[32:35]
v_mfma_f32_16x16x32_bf16 v[32:35], v[112:115], v[80:83], v[32:35]
v_mfma_f32_16x16x32_bf16 v[32:35], v[116:119], v[84:87], v[32:35]
v_mfma_f32_16x16x32_bf16 v[32:35], v[120:123], v[88:91], v[32:35]
v_mfma_f32_16x16x32_bf16 v[32:35], v[124:127], v[92:95], v[32:35]
v_mfma_f32_16x16x32_bf16 v[36:39], v[128:131], v[64:67], v[28:31]
v_mfma_f32_16x16x32_bf16 v[36:39], v[132:135], v[68:71], v[36:39]
v_mfma_f32_16x16x32_bf16 v[36:39], v[136:139], v[72:75], v[36:39]
v_mfma_f32_16x16x32_bf16 v[36:39], v[140:143], v[76:79], v[36:39]
v_mfma_f32_16x16x32_bf16 v[36:39], v[144:147], v[80:83], v[36:39]
v_mfma_f32_16x16x32_bf16 v[36:39], v[148:151], v[84:87], v[36:39]
v_mfma_f32_16x16x32_bf16 v[36:39], v[152:155], v[88:91], v[36:39]
v_mfma_f32_16x16x32_bf16 v[36:39], v[156:159], v[92:95], v[36:39]
s_waitcnt vmcnt(16)
ds_read_b128 v[96:99], v6 offset:0
ds_read_b128 v[100:103], v7 offset:0
ds_read_b128 v[104:107], v8 offset:0
ds_read_b128 v[108:111], v9 offset:0
ds_read_b128 v[112:115], v6 offset:256
ds_read_b128 v[116:119], v7 offset:256
ds_read_b128 v[120:123], v8 offset:256
ds_read_b128 v[124:127], v9 offset:256
ds_read_b128 v[128:131], v6 offset:8192
ds_read_b128 v[132:135], v7 offset:8192
ds_read_b128 v[136:139], v8 offset:8192
ds_read_b128 v[140:143], v9 offset:8192
ds_read_b128 v[144:147], v6 offset:8448
ds_read_b128 v[148:151], v7 offset:8448
ds_read_b128 v[152:155], v8 offset:8448
ds_read_b128 v[156:159], v9 offset:8448
s_mov_b32 s45, 4
s_brev_b32 s45, s45
s_lshr_b32 s45, s45, 28
s_lshl_b32 s45, s45, 17
s_add_u32 s45, s45, s44
s_waitcnt lgkmcnt(0)
s_waitcnt vmcnt(4)
s_add_u32 m0, s47, 0
s_add_u32 s46, s45, 0
buffer_load_dwordx4 v2, s[36:39], s46 offen offset:0 sc0 sc1 nt lds
v_mfma_f32_16x16x32_bf16 v[44:47], v[160:163], v[64:67], v[28:31]
v_mfma_f32_16x16x32_bf16 v[44:47], v[164:167], v[68:71], v[44:47]
v_mfma_f32_16x16x32_bf16 v[44:47], v[168:171], v[72:75], v[44:47]
v_mfma_f32_16x16x32_bf16 v[44:47], v[172:175], v[76:79], v[44:47]
v_mfma_f32_16x16x32_bf16 v[44:47], v[176:179], v[80:83], v[44:47]
v_mfma_f32_16x16x32_bf16 v[44:47], v[180:183], v[84:87], v[44:47]
v_mfma_f32_16x16x32_bf16 v[44:47], v[184:187], v[88:91], v[44:47]
v_mfma_f32_16x16x32_bf16 v[44:47], v[188:191], v[92:95], v[44:47]
v_mfma_f32_16x16x32_bf16 v[48:51], v[192:195], v[64:67], v[28:31]
v_mfma_f32_16x16x32_bf16 v[48:51], v[196:199], v[68:71], v[48:51]
v_mfma_f32_16x16x32_bf16 v[48:51], v[200:203], v[72:75], v[48:51]
v_mfma_f32_16x16x32_bf16 v[48:51], v[204:207], v[76:79], v[48:51]
v_mfma_f32_16x16x32_bf16 v[48:51], v[208:211], v[80:83], v[48:51]
v_mfma_f32_16x16x32_bf16 v[48:51], v[212:215], v[84:87], v[48:51]
v_mfma_f32_16x16x32_bf16 v[48:51], v[216:219], v[88:91], v[48:51]
v_mfma_f32_16x16x32_bf16 v[48:51], v[220:223], v[92:95], v[48:51]
s_waitcnt vmcnt(4)
buffer_load_dwordx4 v3, s[36:39], s46 offen offset:1024 sc0 sc1 nt lds
v_max3_f32 v18, v18, v32, v33
v_max3_f32 v18, v18, v34, v35
v_max3_f32 v18, v18, v36, v37
v_max3_f32 v18, v18, v38, v39
s_mov_b64 exec, s[58:59]
ds_write_b128 v55, v[32:35]
ds_write_b128 v55, v[36:39] offset:16
s_mov_b64 exec, -1
v_add_u32 v55, 256, v55
s_waitcnt vmcnt(4)
buffer_load_dwordx4 v4, s[36:39], s46 offen offset:2048 sc0 sc1 nt lds
s_waitcnt lgkmcnt(0)
v_mfma_f32_16x16x32_bf16 v[32:35], v[96:99], v[64:67], v[28:31]
v_mfma_f32_16x16x32_bf16 v[32:35], v[100:103], v[68:71], v[32:35]
v_mfma_f32_16x16x32_bf16 v[32:35], v[104:107], v[72:75], v[32:35]
v_mfma_f32_16x16x32_bf16 v[32:35], v[108:111], v[76:79], v[32:35]
v_mfma_f32_16x16x32_bf16 v[32:35], v[112:115], v[80:83], v[32:35]
v_mfma_f32_16x16x32_bf16 v[32:35], v[116:119], v[84:87], v[32:35]
v_mfma_f32_16x16x32_bf16 v[32:35], v[120:123], v[88:91], v[32:35]
v_mfma_f32_16x16x32_bf16 v[32:35], v[124:127], v[92:95], v[32:35]
v_mfma_f32_16x16x32_bf16 v[36:39], v[128:131], v[64:67], v[28:31]
v_mfma_f32_16x16x32_bf16 v[36:39], v[132:135], v[68:71], v[36:39]
v_mfma_f32_16x16x32_bf16 v[36:39], v[136:139], v[72:75], v[36:39]
v_mfma_f32_16x16x32_bf16 v[36:39], v[140:143], v[76:79], v[36:39]
v_mfma_f32_16x16x32_bf16 v[36:39], v[144:147], v[80:83], v[36:39]
v_mfma_f32_16x16x32_bf16 v[36:39], v[148:151], v[84:87], v[36:39]
v_mfma_f32_16x16x32_bf16 v[36:39], v[152:155], v[88:91], v[36:39]
v_mfma_f32_16x16x32_bf16 v[36:39], v[156:159], v[92:95], v[36:39]
s_waitcnt vmcnt(4)
buffer_load_dwordx4 v5, s[36:39], s46 offen offset:3072 sc0 sc1 nt lds
v_max3_f32 v18, v18, v44, v45
v_max3_f32 v18, v18, v46, v47
v_max3_f32 v18, v18, v48, v49
v_max3_f32 v18, v18, v50, v51
s_mov_b64 exec, s[58:59]
ds_write_b128 v55, v[44:47]
ds_write_b128 v55, v[48:51] offset:16
s_mov_b64 exec, -1
v_add_u32 v55, 256, v55
s_waitcnt vmcnt(4)
s_add_u32 m0, s47, 4096
s_add_u32 s46, s45, 2097152
buffer_load_dwordx4 v2, s[36:39], s46 offen offset:0 sc0 sc1 nt lds
ds_read_b128 v[96:99], v6 offset:16384
ds_read_b128 v[100:103], v7 offset:16384
ds_read_b128 v[104:107], v8 offset:16384
ds_read_b128 v[108:111], v9 offset:16384
ds_read_b128 v[112:115], v6 offset:16640
ds_read_b128 v[116:119], v7 offset:16640
ds_read_b128 v[120:123], v8 offset:16640
ds_read_b128 v[124:127], v9 offset:16640
ds_read_b128 v[128:131], v6 offset:24576
ds_read_b128 v[132:135], v7 offset:24576
ds_read_b128 v[136:139], v8 offset:24576
ds_read_b128 v[140:143], v9 offset:24576
ds_read_b128 v[144:147], v6 offset:24832
ds_read_b128 v[148:151], v7 offset:24832
ds_read_b128 v[152:155], v8 offset:24832
ds_read_b128 v[156:159], v9 offset:24832
s_waitcnt vmcnt(4)
buffer_load_dwordx4 v3, s[36:39], s46 offen offset:1024 sc0 sc1 nt lds
v_max3_f32 v18, v18, v32, v33
v_max3_f32 v18, v18, v34, v35
v_max3_f32 v18, v18, v36, v37
v_max3_f32 v18, v18, v38, v39
s_mov_b64 exec, s[58:59]
ds_write_b128 v55, v[32:35]
ds_write_b128 v55, v[36:39] offset:16
s_mov_b64 exec, -1
v_add_u32 v55, 256, v55
s_waitcnt vmcnt(4)
buffer_load_dwordx4 v4, s[36:39], s46 offen offset:2048 sc0 sc1 nt lds
s_waitcnt lgkmcnt(0)
v_mfma_f32_16x16x32_bf16 v[44:47], v[96:99], v[64:67], v[28:31]
v_mfma_f32_16x16x32_bf16 v[44:47], v[100:103], v[68:71], v[44:47]
v_mfma_f32_16x16x32_bf16 v[44:47], v[104:107], v[72:75], v[44:47]
v_mfma_f32_16x16x32_bf16 v[44:47], v[108:111], v[76:79], v[44:47]
v_mfma_f32_16x16x32_bf16 v[44:47], v[112:115], v[80:83], v[44:47]
v_mfma_f32_16x16x32_bf16 v[44:47], v[116:119], v[84:87], v[44:47]
v_mfma_f32_16x16x32_bf16 v[44:47], v[120:123], v[88:91], v[44:47]
v_mfma_f32_16x16x32_bf16 v[44:47], v[124:127], v[92:95], v[44:47]
v_mfma_f32_16x16x32_bf16 v[48:51], v[128:131], v[64:67], v[28:31]
v_mfma_f32_16x16x32_bf16 v[48:51], v[132:135], v[68:71], v[48:51]
v_mfma_f32_16x16x32_bf16 v[48:51], v[136:139], v[72:75], v[48:51]
v_mfma_f32_16x16x32_bf16 v[48:51], v[140:143], v[76:79], v[48:51]
v_mfma_f32_16x16x32_bf16 v[48:51], v[144:147], v[80:83], v[48:51]
v_mfma_f32_16x16x32_bf16 v[48:51], v[148:151], v[84:87], v[48:51]
v_mfma_f32_16x16x32_bf16 v[48:51], v[152:155], v[88:91], v[48:51]
v_mfma_f32_16x16x32_bf16 v[48:51], v[156:159], v[92:95], v[48:51]
s_waitcnt vmcnt(4)
buffer_load_dwordx4 v5, s[36:39], s46 offen offset:3072 sc0 sc1 nt lds
s_waitcnt vmcnt(4)
s_add_u32 m0, s47, 8192
s_add_u32 s46, s45, 4194304
buffer_load_dwordx4 v2, s[36:39], s46 offen offset:0 sc0 sc1 nt lds
s_nop 7
v_max3_f32 v18, v18, v44, v45
v_max3_f32 v18, v18, v46, v47
v_max3_f32 v18, v18, v48, v49
v_max3_f32 v18, v18, v50, v51
s_mov_b64 exec, s[58:59]
ds_write_b128 v55, v[44:47]
ds_write_b128 v55, v[48:51] offset:16
s_mov_b64 exec, -1
v_add_u32 v55, 256, v55
s_waitcnt vmcnt(4)
buffer_load_dwordx4 v3, s[36:39], s46 offen offset:1024 sc0 sc1 nt lds
v_mov_b32 v160, 0
v_mov_b32 v161, 0
v_mov_b32 v162, 0
v_mov_b32 v163, 0
v_mov_b32 v164, 0
v_mov_b32 v165, 0
v_mov_b32 v166, 0
v_mov_b32 v167, 0
v_mov_b32 v168, 0
v_mov_b32 v169, 0
v_mov_b32 v170, 0
v_mov_b32 v171, 0
v_mov_b32 v172, 0
v_mov_b32 v173, 0
v_mov_b32 v174, 0
v_mov_b32 v175, 0
s_waitcnt vmcnt(4)
buffer_load_dwordx4 v4, s[36:39], s46 offen offset:2048 sc0 sc1 nt lds
v_mov_b32 v176, 0
v_mov_b32 v177, 0
v_mov_b32 v178, 0
v_mov_b32 v179, 0
v_mov_b32 v180, 0
v_mov_b32 v181, 0
v_mov_b32 v182, 0
v_mov_b32 v183, 0
v_mov_b32 v184, 0
v_mov_b32 v185, 0
v_mov_b32 v186, 0
v_mov_b32 v187, 0
v_mov_b32 v188, 0
v_mov_b32 v189, 0
v_mov_b32 v190, 0
v_mov_b32 v191, 0
s_waitcnt vmcnt(4)
buffer_load_dwordx4 v5, s[36:39], s46 offen offset:3072 sc0 sc1 nt lds
v_mov_b32 v192, 0
v_mov_b32 v193, 0
v_mov_b32 v194, 0
v_mov_b32 v195, 0
v_mov_b32 v196, 0
v_mov_b32 v197, 0
v_mov_b32 v198, 0
v_mov_b32 v199, 0
v_mov_b32 v200, 0
v_mov_b32 v201, 0
v_mov_b32 v202, 0
v_mov_b32 v203, 0
v_mov_b32 v204, 0
v_mov_b32 v205, 0
v_mov_b32 v206, 0
v_mov_b32 v207, 0
s_waitcnt vmcnt(4)
s_add_u32 m0, s47, 12288
s_add_u32 s46, s45, 6291456
buffer_load_dwordx4 v2, s[36:39], s46 offen offset:0 sc0 sc1 nt lds
v_mov_b32 v208, 0
v_mov_b32 v209, 0
v_mov_b32 v210, 0
v_mov_b32 v211, 0
v_mov_b32 v212, 0
v_mov_b32 v213, 0
v_mov_b32 v214, 0
v_mov_b32 v215, 0
v_mov_b32 v216, 0
v_mov_b32 v217, 0
v_mov_b32 v218, 0
v_mov_b32 v219, 0
v_mov_b32 v220, 0
v_mov_b32 v221, 0
v_mov_b32 v222, 0
v_mov_b32 v223, 0
s_waitcnt vmcnt(4)
buffer_load_dwordx4 v3, s[36:39], s46 offen offset:1024 sc0 sc1 nt lds
s_waitcnt vmcnt(4)
buffer_load_dwordx4 v4, s[36:39], s46 offen offset:2048 sc0 sc1 nt lds
s_waitcnt vmcnt(4)
buffer_load_dwordx4 v5, s[36:39], s46 offen offset:3072 sc0 sc1 nt lds
s_mov_b32 s66, 4
s_mov_b32 s45, 5
s_brev_b32 s45, s45
s_lshr_b32 s45, s45, 28
s_lshl_b32 s45, s45, 17
s_add_u32 s45, s45, s44
s_add_u32 s64, s47, 0x4000
L_KA:
s_waitcnt vmcnt(4)
s_add_u32 m0, s64, 0
s_add_u32 s46, s45, 0
buffer_load_dwordx4 v2, s[36:39], s46 offen offset:0 sc0 sc1 nt lds
ds_read_b128 v[96:99], v6 offset:0
ds_read_b128 v[100:103], v7 offset:0
ds_read_b128 v[104:107], v8 offset:0
ds_read_b128 v[108:111], v9 offset:0
ds_read_b128 v[112:115], v6 offset:256
ds_read_b128 v[116:119], v7 offset:256
ds_read_b128 v[120:123], v8 offset:256
ds_read_b128 v[124:127], v9 offset:256
s_waitcnt vmcnt(4)
buffer_load_dwordx4 v3, s[36:39], s46 offen offset:1024 sc0 sc1 nt lds
s_waitcnt lgkmcnt(0)
v_mfma_f32_16x16x32_bf16 v[32:35], v[96:99], v[64:67], v[28:31]
v_mfma_f32_16x16x32_bf16 v[32:35], v[100:103], v[68:71], v[32:35]
v_mfma_f32_16x16x32_bf16 v[32:35], v[104:107], v[72:75], v[32:35]
v_mfma_f32_16x16x32_bf16 v[32:35], v[108:111], v[76:79], v[32:35]
v_mfma_f32_16x16x32_bf16 v[32:35], v[112:115], v[80:83], v[32:35]
v_mfma_f32_16x16x32_bf16 v[32:35], v[116:119], v[84:87], v[32:35]
v_mfma_f32_16x16x32_bf16 v[32:35], v[120:123], v[88:91], v[32:35]
v_mfma_f32_16x16x32_bf16 v[32:35], v[124:127], v[92:95], v[32:35]
s_waitcnt vmcnt(4)
buffer_load_dwordx4 v4, s[36:39], s46 offen offset:2048 sc0 sc1 nt lds
s_waitcnt vmcnt(4)
buffer_load_dwordx4 v5, s[36:39], s46 offen offset:3072 sc0 sc1 nt lds
s_waitcnt vmcnt(4)
s_add_u32 m0, s64, 4096
s_add_u32 s46, s45, 2097152
buffer_load_dwordx4 v2, s[36:39], s46 offen offset:0 sc0 sc1 nt lds
ds_read_b128 v[128:131], v6 offset:8192
ds_read_b128 v[132:135], v7 offset:8192
ds_read_b128 v[136:139], v8 offset:8192
ds_read_b128 v[140:143], v9 offset:8192
ds_read_b128 v[144:147], v6 offset:8448
ds_read_b128 v[148:151], v7 offset:8448
ds_read_b128 v[152:155], v8 offset:8448
ds_read_b128 v[156:159], v9 offset:8448
s_waitcnt vmcnt(4)
buffer_load_dwordx4 v3, s[36:39], s46 offen offset:1024 sc0 sc1 nt lds
s_waitcnt lgkmcnt(0)
v_mfma_f32_16x16x32_bf16 v[36:39], v[128:131], v[64:67], v[28:31]
v_mfma_f32_16x16x32_bf16 v[36:39], v[132:135], v[68:71], v[36:39]
v_mfma_f32_16x16x32_bf16 v[36:39], v[136:139], v[72:75], v[36:39]
v_mfma_f32_16x16x32_bf16 v[36:39], v[140:143], v[76:79], v[36:39]
v_mfma_f32_16x16x32_bf16 v[36:39], v[144:147], v[80:83], v[36:39]
v_mfma_f32_16x16x32_bf16 v[36:39], v[148:151], v[84:87], v[36:39]
v_mfma_f32_16x16x32_bf16 v[36:39], v[152:155], v[88:91], v[36:39]
v_mfma_f32_16x16x32_bf16 v[36:39], v[156:159], v[92:95], v[36:39]
s_waitcnt vmcnt(4)
buffer_load_dwordx4 v4, s[36:39], s46 offen offset:2048 sc0 sc1 nt lds
s_nop 7
v_max3_f32 v18, v18, v32, v33
v_max3_f32 v18, v18, v34, v35
v_max3_f32 v18, v18, v36, v37
v_max3_f32 v18, v18, v38, v39
s_mov_b64 exec, s[58:59]
ds_write_b128 v55, v[32:35]
ds_write_b128 v55, v[36:39] offset:16
s_mov_b64 exec, -1
v_add_u32 v55, 256, v55
s_waitcnt vmcnt(4)
buffer_load_dwordx4 v5, s[36:39], s46 offen offset:3072 sc0 sc1 nt lds
s_waitcnt vmcnt(4)
s_add_u32 m0, s64, 8192
s_add_u32 s46, s45, 4194304
buffer_load_dwordx4 v2, s[36:39], s46 offen offset:0 sc0 sc1 nt lds
s_waitcnt vmcnt(4)
buffer_load_dwordx4 v3, s[36:39], s46 offen offset:1024 sc0 sc1 nt lds
s_waitcnt vmcnt(4)
buffer_load_dwordx4 v4, s[36:39], s46 offen offset:2048 sc0 sc1 nt lds
s_waitcnt vmcnt(4)
buffer_load_dwordx4 v5, s[36:39], s46 offen offset:3072 sc0 sc1 nt lds
s_waitcnt vmcnt(4)
s_add_u32 m0, s64, 12288
s_add_u32 s46, s45, 6291456
buffer_load_dwordx4 v2, s[36:39], s46 offen offset:0 sc0 sc1 nt lds
s_waitcnt vmcnt(4)
buffer_load_dwordx4 v3, s[36:39], s46 offen offset:1024 sc0 sc1 nt lds
s_waitcnt vmcnt(4)
buffer_load_dwordx4 v4, s[36:39], s46 offen offset:2048 sc0 sc1 nt lds
s_waitcnt vmcnt(4)
buffer_load_dwordx4 v5, s[36:39], s46 offen offset:3072 sc0 sc1 nt lds
v_xor_b32 v6, 0x4000, v6
v_xor_b32 v7, 0x4000, v7
v_xor_b32 v8, 0x4000, v8
v_xor_b32 v9, 0x4000, v9
v_xor_b32 v10, 0x4000, v10
v_xor_b32 v11, 0x4000, v11
v_xor_b32 v12, 0x4000, v12
v_xor_b32 v13, 0x4000, v13
v_xor_b32 v14, 0x4000, v14
v_xor_b32 v15, 0x4000, v15
v_xor_b32 v16, 0x4000, v16
v_xor_b32 v17, 0x4000, v17
s_xor_b32 s64, s64, 0x4000
s_add_u32 s66, s66, 1
s_add_u32 s65, s66, 1
s_cmp_lt_u32 s65, 16
s_cbranch_scc1 L_nx_1
s_mov_b32 s36, s50
s_mov_b32 s37, s51
s_mov_b32 s38, 0x800000
s_mov_b32 s65, 0
L_nx_1:
s_and_b32 s62, s65, 15
s_mov_b32 s45, s62
s_brev_b32 s45, s45
s_lshr_b32 s45, s45, 28
s_lshl_b32 s45, s45, 17
s_lshr_b32 s62, s65, 4
s_lshl_b32 s62, s62, 28
s_add_u32 s45, s45, s62
s_add_u32 s45, s45, s44
s_cmp_lt_u32 s66, 16
s_cbranch_scc1 L_KA
ds_swizzle_b32 v22, v18 offset:0x401F
s_waitcnt lgkmcnt(0)
v_max_f32 v18, v18, v22
v_mov_b32 v22, v18
s_nop 1
v_permlane32_swap_b32 v18, v22
s_nop 1
v_max_f32 v18, v18, v22
v_mul_f32 v56, s61, v18
v_cmp_gt_u32 vcc, 2, v21
v_mov_b32 v22, 0xff800000
s_nop 0
v_cndmask_b32 v20, v22, v56, vcc
v_lshrrev_b32 v22, 4, v0
v_lshlrev_b32 v22, 6, v22
v_and_b32 v23, 1, v0
v_lshl_add_u32 v22, v23, 5, v22
v_add_u32 v55, s57, v22
s_mov_b32 s66, 0
s_mov_b32 s65, 1
s_and_b32 s62, s65, 15
s_mov_b32 s45, s62
s_brev_b32 s45, s45
s_lshr_b32 s45, s45, 28
s_lshl_b32 s45, s45, 17
s_lshr_b32 s62, s65, 4
s_lshl_b32 s62, s62, 28
s_add_u32 s45, s45, s62
s_add_u32 s45, s45, s44
L_VA:
s_waitcnt vmcnt(4)
s_add_u32 m0, s64, 0
s_add_u32 s46, s45, 0
buffer_load_dwordx4 v2, s[36:39], s46 offen offset:0 sc0 sc1 nt lds
ds_read_b128 v[32:35], v55
ds_read_b128 v[36:39], v55 offset:16
v_add_u32 v55, 256, v55
ds_read_b64_tr_b16 v[96:97], v10 offset:0
ds_read_b64_tr_b16 v[100:101], v11 offset:0
ds_read_b64_tr_b16 v[104:105], v12 offset:0
ds_read_b64_tr_b16 v[108:109], v13 offset:0
ds_read_b64_tr_b16 v[112:113], v14 offset:0
ds_read_b64_tr_b16 v[116:117], v15 offset:0
ds_read_b64_tr_b16 v[120:121], v16 offset:0
ds_read_b64_tr_b16 v[124:125], v17 offset:0
ds_read_b64_tr_b16 v[128:129], v10 offset:256
ds_read_b64_tr_b16 v[132:133], v11 offset:256
ds_read_b64_tr_b16 v[136:137], v12 offset:256
ds_read_b64_tr_b16 v[140:141], v13 offset:256
ds_read_b64_tr_b16 v[144:145], v14 offset:256
ds_read_b64_tr_b16 v[148:149], v15 offset:256
ds_read_b64_tr_b16 v[152:153], v16 offset:256
ds_read_b64_tr_b16 v[156:157], v17 offset:256
s_waitcnt vmcnt(4)
buffer_load_dwordx4 v3, s[36:39], s46 offen offset:1024 sc0 sc1 nt lds
s_waitcnt lgkmcnt(0)
v_fma_f32 v44, v32, s60, v20
v_fma_f32 v45, v33, s60, v20
v_fma_f32 v46, v34, s60, v20
v_fma_f32 v47, v35, s60, v20
v_exp_f32 v44, v44
v_exp_f32 v45, v45
v_exp_f32 v46, v46
v_exp_f32 v47, v47
s_waitcnt vmcnt(4)
buffer_load_dwordx4 v4, s[36:39], s46 offen offset:2048 sc0 sc1 nt lds
v_fma_f32 v48, v36, s60, v20
v_fma_f32 v49, v37, s60, v20
v_fma_f32 v50, v38, s60, v20
v_fma_f32 v51, v39, s60, v20
v_exp_f32 v48, v48
v_exp_f32 v49, v49
v_exp_f32 v50, v50
v_exp_f32 v51, v51
s_waitcnt vmcnt(4)
buffer_load_dwordx4 v5, s[36:39], s46 offen offset:3072 sc0 sc1 nt lds
s_nop 0
v_cvt_pk_bf16_f32 v40, v44, v45
v_cvt_pk_bf16_f32 v41, v46, v47
v_cvt_pk_bf16_f32 v42, v48, v49
v_cvt_pk_bf16_f32 v43, v50, v51
v_add_f32 v22, v44, v45
v_add_f32 v23, v46, v47
v_add_f32 v24, v48, v49
v_add_f32 v25, v50, v51
v_add_f32 v22, v22, v23
v_add_f32 v24, v24, v25
v_add_f32 v22, v22, v24
v_add_f32 v19, v19, v22
s_waitcnt vmcnt(4)
s_add_u32 m0, s64, 4096
s_add_u32 s46, s45, 2097152
buffer_load_dwordx4 v2, s[36:39], s46 offen offset:0 sc0 sc1 nt lds
ds_read_b64_tr_b16 v[98:99], v10 offset:8192
ds_read_b64_tr_b16 v[102:103], v11 offset:8192
ds_read_b64_tr_b16 v[106:107], v12 offset:8192
ds_read_b64_tr_b16 v[110:111], v13 offset:8192
ds_read_b64_tr_b16 v[114:115], v14 offset:8192
ds_read_b64_tr_b16 v[118:119], v15 offset:8192
ds_read_b64_tr_b16 v[122:123], v16 offset:8192
ds_read_b64_tr_b16 v[126:127], v17 offset:8192
ds_read_b64_tr_b16 v[130:131], v10 offset:8448
ds_read_b64_tr_b16 v[134:135], v11 offset:8448
ds_read_b64_tr_b16 v[138:139], v12 offset:8448
ds_read_b64_tr_b16 v[142:143], v13 offset:8448
ds_read_b64_tr_b16 v[146:147], v14 offset:8448
ds_read_b64_tr_b16 v[150:151], v15 offset:8448
ds_read_b64_tr_b16 v[154:155], v16 offset:8448
ds_read_b64_tr_b16 v[158:159], v17 offset:8448
s_waitcnt vmcnt(4)
buffer_load_dwordx4 v3, s[36:39], s46 offen offset:1024 sc0 sc1 nt lds
s_waitcnt lgkmcnt(0)
v_mfma_f32_16x16x32_bf16 v[160:163], v[96:99], v[40:43], v[160:163]
v_mfma_f32_16x16x32_bf16 v[164:167], v[100:103], v[40:43], v[164:167]
v_mfma_f32_16x16x32_bf16 v[168:171], v[104:107], v[40:43], v[168:171]
v_mfma_f32_16x16x32_bf16 v[172:175], v[108:111], v[40:43], v[172:175]
s_waitcnt vmcnt(4)
buffer_load_dwordx4 v4, s[36:39], s46 offen offset:2048 sc0 sc1 nt lds
v_mfma_f32_16x16x32_bf16 v[176:179], v[112:115], v[40:43], v[176:179]
v_mfma_f32_16x16x32_bf16 v[180:183], v[116:119], v[40:43], v[180:183]
v_mfma_f32_16x16x32_bf16 v[184:187], v[120:123], v[40:43], v[184:187]
v_mfma_f32_16x16x32_bf16 v[188:191], v[124:127], v[40:43], v[188:191]
s_waitcnt vmcnt(4)
buffer_load_dwordx4 v5, s[36:39], s46 offen offset:3072 sc0 sc1 nt lds
v_mfma_f32_16x16x32_bf16 v[192:195], v[128:131], v[40:43], v[192:195]
v_mfma_f32_16x16x32_bf16 v[196:199], v[132:135], v[40:43], v[196:199]
v_mfma_f32_16x16x32_bf16 v[200:203], v[136:139], v[40:43], v[200:203]
v_mfma_f32_16x16x32_bf16 v[204:207], v[140:143], v[40:43], v[204:207]
s_waitcnt vmcnt(4)
s_add_u32 m0, s64, 8192
s_add_u32 s46, s45, 4194304
buffer_load_dwordx4 v2, s[36:39], s46 offen offset:0 sc0 sc1 nt lds
v_mfma_f32_16x16x32_bf16 v[208:211], v[144:147], v[40:43], v[208:211]
v_mfma_f32_16x16x32_bf16 v[212:215], v[148:151], v[40:43], v[212:215]
v_mfma_f32_16x16x32_bf16 v[216:219], v[152:155], v[40:43], v[216:219]
v_mfma_f32_16x16x32_bf16 v[220:223], v[156:159], v[40:43], v[220:223]
s_waitcnt vmcnt(4)
buffer_load_dwordx4 v3, s[36:39], s46 offen offset:1024 sc0 sc1 nt lds
s_waitcnt vmcnt(4)
buffer_load_dwordx4 v4, s[36:39], s46 offen offset:2048 sc0 sc1 nt lds
s_waitcnt vmcnt(4)
buffer_load_dwordx4 v5, s[36:39], s46 offen offset:3072 sc0 sc1 nt lds
s_waitcnt vmcnt(4)
s_add_u32 m0, s64, 12288
s_add_u32 s46, s45, 6291456
buffer_load_dwordx4 v2, s[36:39], s46 offen offset:0 sc0 sc1 nt lds
s_waitcnt vmcnt(4)
buffer_load_dwordx4 v3, s[36:39], s46 offen offset:1024 sc0 sc1 nt lds
s_waitcnt vmcnt(4)
buffer_load_dwordx4 v4, s[36:39], s46 offen offset:2048 sc0 sc1 nt lds
s_waitcnt vmcnt(4)
buffer_load_dwordx4 v5, s[36:39], s46 offen offset:3072 sc0 sc1 nt lds
v_xor_b32 v6, 0x4000, v6
v_xor_b32 v7, 0x4000, v7
v_xor_b32 v8, 0x4000, v8
v_xor_b32 v9, 0x4000, v9
v_xor_b32 v10, 0x4000, v10
v_xor_b32 v11, 0x4000, v11
v_xor_b32 v12, 0x4000, v12
v_xor_b32 v13, 0x4000, v13
v_xor_b32 v14, 0x4000, v14
v_xor_b32 v15, 0x4000, v15
v_xor_b32 v16, 0x4000, v16
v_xor_b32 v17, 0x4000, v17
s_xor_b32 s64, s64, 0x4000
s_add_u32 s66, s66, 1
s_add_u32 s65, s66, 1
s_cmp_lt_u32 s65, 16
s_cbranch_scc1 L_nx_3
s_mov_b32 s36, s52
s_mov_b32 s37, s53
s_mov_b32 s38, 0x10800000
s_mov_b32 s65, 0
L_nx_3:
s_and_b32 s62, s65, 15
s_mov_b32 s45, s62
s_brev_b32 s45, s45
s_lshr_b32 s45, s45, 28
s_lshl_b32 s45, s45, 17
s_lshr_b32 s62, s65, 4
s_lshl_b32 s62, s62, 28
s_add_u32 s45, s45, s62
s_add_u32 s45, s45, s44
s_cmp_lt_u32 s66, 16
s_cbranch_scc1 L_VA
v_cmp_eq_u32 vcc, 2, v21
v_mov_b32 v22, 0xff800000
v_mov_b32 v23, 0
v_cndmask_b32 v28, v22, v23, vcc
v_cndmask_b32 v29, v22, v23, vcc
v_cndmask_b32 v30, v22, v23, vcc
v_cndmask_b32 v31, v22, v23, vcc
s_mov_b32 s58, 0x00040004
s_mov_b32 s59, 0x00040004
v_lshrrev_b32 v22, 4, v0
v_lshlrev_b32 v22, 5, v22
v_add_u32 v55, s57, v22
s_mov_b32 s66, 0
s_mov_b32 s65, 1
s_and_b32 s62, s65, 15
s_mov_b32 s45, s62
s_brev_b32 s45, s45
s_lshr_b32 s45, s45, 28
s_lshl_b32 s45, s45, 17
s_lshr_b32 s62, s65, 4
s_lshl_b32 s62, s62, 28
s_add_u32 s45, s45, s62
s_add_u32 s45, s45, s44
L_KB:
s_waitcnt vmcnt(4)
s_add_u32 m0, s64, 0
s_add_u32 s46, s45, 0
buffer_load_dwordx4 v2, s[36:39], s46 offen offset:0 sc0 sc1 nt lds
ds_read_b128 v[96:99], v6 offset:0
ds_read_b128 v[100:103], v7 offset:0
ds_read_b128 v[104:107], v8 offset:0
ds_read_b128 v[108:111], v9 offset:0
ds_read_b128 v[112:115], v6 offset:256
ds_read_b128 v[116:119], v7 offset:256
ds_read_b128 v[120:123], v8 offset:256
ds_read_b128 v[124:127], v9 offset:256
s_waitcnt vmcnt(4)
buffer_load_dwordx4 v3, s[36:39], s46 offen offset:1024 sc0 sc1 nt lds
s_waitcnt lgkmcnt(0)
v_mfma_f32_16x16x32_bf16 v[32:35], v[96:99], v[64:67], v[28:31]
v_mfma_f32_16x16x32_bf16 v[32:35], v[100:103], v[68:71], v[32:35]
v_mfma_f32_16x16x32_bf16 v[32:35], v[104:107], v[72:75], v[32:35]
v_mfma_f32_16x16x32_bf16 v[32:35], v[108:111], v[76:79], v[32:35]
v_mfma_f32_16x16x32_bf16 v[32:35], v[112:115], v[80:83], v[32:35]
v_mfma_f32_16x16x32_bf16 v[32:35], v[116:119], v[84:87], v[32:35]
v_mfma_f32_16x16x32_bf16 v[32:35], v[120:123], v[88:91], v[32:35]
v_mfma_f32_16x16x32_bf16 v[32:35], v[124:127], v[92:95], v[32:35]
s_waitcnt vmcnt(4)
buffer_load_dwordx4 v4, s[36:39], s46 offen offset:2048 sc0 sc1 nt lds
s_waitcnt vmcnt(4)
buffer_load_dwordx4 v5, s[36:39], s46 offen offset:3072 sc0 sc1 nt lds
s_waitcnt vmcnt(4)
s_add_u32 m0, s64, 4096
s_add_u32 s46, s45, 2097152
buffer_load_dwordx4 v2, s[36:39], s46 offen offset:0 sc0 sc1 nt lds
ds_read_b128 v[128:131], v6 offset:8192
ds_read_b128 v[132:135], v7 offset:8192
ds_read_b128 v[136:139], v8 offset:8192
ds_read_b128 v[140:143], v9 offset:8192
ds_read_b128 v[144:147], v6 offset:8448
ds_read_b128 v[148:151], v7 offset:8448
ds_read_b128 v[152:155], v8 offset:8448
ds_read_b128 v[156:159], v9 offset:8448
s_waitcnt vmcnt(4)
buffer_load_dwordx4 v3, s[36:39], s46 offen offset:1024 sc0 sc1 nt lds
s_waitcnt lgkmcnt(0)
v_mfma_f32_16x16x32_bf16 v[36:39], v[128:131], v[64:67], v[28:31]
v_mfma_f32_16x16x32_bf16 v[36:39], v[132:135], v[68:71], v[36:39]
v_mfma_f32_16x16x32_bf16 v[36:39], v[136:139], v[72:75], v[36:39]
v_mfma_f32_16x16x32_bf16 v[36:39], v[140:143], v[76:79], v[36:39]
v_mfma_f32_16x16x32_bf16 v[36:39], v[144:147], v[80:83], v[36:39]
v_mfma_f32_16x16x32_bf16 v[36:39], v[148:151], v[84:87], v[36:39]
v_mfma_f32_16x16x32_bf16 v[36:39], v[152:155], v[88:91], v[36:39]
v_mfma_f32_16x16x32_bf16 v[36:39], v[156:159], v[92:95], v[36:39]
s_waitcnt vmcnt(4)
buffer_load_dwordx4 v4, s[36:39], s46 offen offset:2048 sc0 sc1 nt lds
s_nop 7
v_max3_f32 v18, v18, v32, v33
v_max3_f32 v18, v18, v34, v35
v_max3_f32 v18, v18, v36, v37
v_max3_f32 v18, v18, v38, v39
s_mov_b64 exec, s[58:59]
ds_write_b128 v55, v[32:35]
ds_write_b128 v55, v[36:39] offset:16
s_mov_b64 exec, -1
v_add_u32 v55, 128, v55
s_waitcnt vmcnt(4)
buffer_load_dwordx4 v5, s[36:39], s46 offen offset:3072 sc0 sc1 nt lds
s_waitcnt vmcnt(4)
s_add_u32 m0, s64, 8192
s_add_u32 s46, s45, 4194304
buffer_load_dwordx4 v2, s[36:39], s46 offen offset:0 sc0 sc1 nt lds
s_waitcnt vmcnt(4)
buffer_load_dwordx4 v3, s[36:39], s46 offen offset:1024 sc0 sc1 nt lds
s_waitcnt vmcnt(4)
buffer_load_dwordx4 v4, s[36:39], s46 offen offset:2048 sc0 sc1 nt lds
s_waitcnt vmcnt(4)
buffer_load_dwordx4 v5, s[36:39], s46 offen offset:3072 sc0 sc1 nt lds
s_waitcnt vmcnt(4)
s_add_u32 m0, s64, 12288
s_add_u32 s46, s45, 6291456
buffer_load_dwordx4 v2, s[36:39], s46 offen offset:0 sc0 sc1 nt lds
s_waitcnt vmcnt(4)
buffer_load_dwordx4 v3, s[36:39], s46 offen offset:1024 sc0 sc1 nt lds
s_waitcnt vmcnt(4)
buffer_load_dwordx4 v4, s[36:39], s46 offen offset:2048 sc0 sc1 nt lds
s_waitcnt vmcnt(4)
buffer_load_dwordx4 v5, s[36:39], s46 offen offset:3072 sc0 sc1 nt lds
v_xor_b32 v6, 0x4000, v6
v_xor_b32 v7, 0x4000, v7
v_xor_b32 v8, 0x4000, v8
v_xor_b32 v9, 0x4000, v9
v_xor_b32 v10, 0x4000, v10
v_xor_b32 v11, 0x4000, v11
v_xor_b32 v12, 0x4000, v12
v_xor_b32 v13, 0x4000, v13
v_xor_b32 v14, 0x4000, v14
v_xor_b32 v15, 0x4000, v15
v_xor_b32 v16, 0x4000, v16
v_xor_b32 v17, 0x4000, v17
s_xor_b32 s64, s64, 0x4000
s_add_u32 s66, s66, 1
s_cmp_eq_u32 s66, 16
s_cbranch_scc0 L_sw_5
v_cmp_eq_u32 vcc, 3, v21
v_mov_b32 v22, 0xff800000
v_mov_b32 v23, 0
v_cndmask_b32 v28, v22, v23, vcc
v_cndmask_b32 v29, v22, v23, vcc
v_cndmask_b32 v30, v22, v23, vcc
v_cndmask_b32 v31, v22, v23, vcc
s_mov_b32 s58, 0x00080008
s_mov_b32 s59, 0x00080008
L_sw_5:
s_add_u32 s65, s66, 1
s_cmp_lt_u32 s65, 29
s_cbranch_scc1 L_nx_6
s_mov_b32 s36, s54
s_mov_b32 s37, s55
s_mov_b32 s38, 0x10800000
s_mov_b32 s65, 0
L_nx_6:
s_and_b32 s62, s65, 15
s_mov_b32 s45, s62
s_brev_b32 s45, s45
s_lshr_b32 s45, s45, 28
s_lshl_b32 s45, s45, 17
s_lshr_b32 s62, s65, 4
s_lshl_b32 s62, s62, 28
s_add_u32 s45, s45, s62
s_add_u32 s45, s45, s44
s_cmp_lt_u32 s66, 29
s_cbranch_scc1 L_KB
ds_swizzle_b32 v22, v18 offset:0x401F
s_waitcnt lgkmcnt(0)
v_max_f32 v18, v18, v22
v_mov_b32 v22, v18
s_nop 1
v_permlane32_swap_b32 v18, v22
s_nop 1
v_max_f32 v18, v18, v22
v_mul_f32 v56, s61, v18
v_cmp_eq_u32 vcc, 2, v21
v_mov_b32 v22, 0xff800000
s_nop 0
v_cndmask_b32 v20, v22, v56, vcc
v_lshrrev_b32 v22, 4, v0
v_lshlrev_b32 v22, 5, v22
v_add_u32 v55, s57, v22
s_mov_b32 s66, 0
s_mov_b32 s65, 1
s_and_b32 s62, s65, 15
s_mov_b32 s45, s62
s_brev_b32 s45, s45
s_lshr_b32 s45, s45, 28
s_lshl_b32 s45, s45, 17
s_lshr_b32 s62, s65, 4
s_lshl_b32 s62, s62, 28
s_add_u32 s45, s45, s62
s_add_u32 s45, s45, s44
L_VB:
s_waitcnt vmcnt(4)
s_add_u32 m0, s64, 0
s_add_u32 s46, s45, 0
buffer_load_dwordx4 v2, s[36:39], s46 offen offset:0 sc0 sc1 nt lds
ds_read_b128 v[32:35], v55
ds_read_b128 v[36:39], v55 offset:16
v_add_u32 v55, 128, v55
ds_read_b64_tr_b16 v[96:97], v10 offset:0
ds_read_b64_tr_b16 v[100:101], v11 offset:0
ds_read_b64_tr_b16 v[104:105], v12 offset:0
ds_read_b64_tr_b16 v[108:109], v13 offset:0
ds_read_b64_tr_b16 v[112:113], v14 offset:0
ds_read_b64_tr_b16 v[116:117], v15 offset:0
ds_read_b64_tr_b16 v[120:121], v16 offset:0
ds_read_b64_tr_b16 v[124:125], v17 offset:0
ds_read_b64_tr_b16 v[128:129], v10 offset:256
ds_read_b64_tr_b16 v[132:133], v11 offset:256
ds_read_b64_tr_b16 v[136:137], v12 offset:256
ds_read_b64_tr_b16 v[140:141], v13 offset:256
ds_read_b64_tr_b16 v[144:145], v14 offset:256
ds_read_b64_tr_b16 v[148:149], v15 offset:256
ds_read_b64_tr_b16 v[152:153], v16 offset:256
ds_read_b64_tr_b16 v[156:157], v17 offset:256
s_waitcnt vmcnt(4)
buffer_load_dwordx4 v3, s[36:39], s46 offen offset:1024 sc0 sc1 nt lds
s_waitcnt lgkmcnt(0)
v_fma_f32 v44, v32, s60, v20
v_fma_f32 v45, v33, s60, v20
v_fma_f32 v46, v34, s60, v20
v_fma_f32 v47, v35, s60, v20
v_exp_f32 v44, v44
v_exp_f32 v45, v45
v_exp_f32 v46, v46
v_exp_f32 v47, v47
s_waitcnt vmcnt(4)
buffer_load_dwordx4 v4, s[36:39], s46 offen offset:2048 sc0 sc1 nt lds
v_fma_f32 v48, v36, s60, v20
v_fma_f32 v49, v37, s60, v20
v_fma_f32 v50, v38, s60, v20
v_fma_f32 v51, v39, s60, v20
v_exp_f32 v48, v48
v_exp_f32 v49, v49
v_exp_f32 v50, v50
v_exp_f32 v51, v51
s_waitcnt vmcnt(4)
buffer_load_dwordx4 v5, s[36:39], s46 offen offset:3072 sc0 sc1 nt lds
s_nop 0
v_cvt_pk_bf16_f32 v40, v44, v45
v_cvt_pk_bf16_f32 v41, v46, v47
v_cvt_pk_bf16_f32 v42, v48, v49
v_cvt_pk_bf16_f32 v43, v50, v51
v_add_f32 v22, v44, v45
v_add_f32 v23, v46, v47
v_add_f32 v24, v48, v49
v_add_f32 v25, v50, v51
v_add_f32 v22, v22, v23
v_add_f32 v24, v24, v25
v_add_f32 v22, v22, v24
v_add_f32 v19, v19, v22
s_waitcnt vmcnt(4)
s_add_u32 m0, s64, 4096
s_add_u32 s46, s45, 2097152
buffer_load_dwordx4 v2, s[36:39], s46 offen offset:0 sc0 sc1 nt lds
ds_read_b64_tr_b16 v[98:99], v10 offset:8192
ds_read_b64_tr_b16 v[102:103], v11 offset:8192
ds_read_b64_tr_b16 v[106:107], v12 offset:8192
ds_read_b64_tr_b16 v[110:111], v13 offset:8192
ds_read_b64_tr_b16 v[114:115], v14 offset:8192
ds_read_b64_tr_b16 v[118:119], v15 offset:8192
ds_read_b64_tr_b16 v[122:123], v16 offset:8192
ds_read_b64_tr_b16 v[126:127], v17 offset:8192
ds_read_b64_tr_b16 v[130:131], v10 offset:8448
ds_read_b64_tr_b16 v[134:135], v11 offset:8448
ds_read_b64_tr_b16 v[138:139], v12 offset:8448
ds_read_b64_tr_b16 v[142:143], v13 offset:8448
ds_read_b64_tr_b16 v[146:147], v14 offset:8448
ds_read_b64_tr_b16 v[150:151], v15 offset:8448
ds_read_b64_tr_b16 v[154:155], v16 offset:8448
ds_read_b64_tr_b16 v[158:159], v17 offset:8448
s_waitcnt vmcnt(4)
buffer_load_dwordx4 v3, s[36:39], s46 offen offset:1024 sc0 sc1 nt lds
s_waitcnt lgkmcnt(0)
v_mfma_f32_16x16x32_bf16 v[160:163], v[96:99], v[40:43], v[160:163]
v_mfma_f32_16x16x32_bf16 v[164:167], v[100:103], v[40:43], v[164:167]
v_mfma_f32_16x16x32_bf16 v[168:171], v[104:107], v[40:43], v[168:171]
v_mfma_f32_16x16x32_bf16 v[172:175], v[108:111], v[40:43], v[172:175]
s_waitcnt vmcnt(4)
buffer_load_dwordx4 v4, s[36:39], s46 offen offset:2048 sc0 sc1 nt lds
v_mfma_f32_16x16x32_bf16 v[176:179], v[112:115], v[40:43], v[176:179]
v_mfma_f32_16x16x32_bf16 v[180:183], v[116:119], v[40:43], v[180:183]
v_mfma_f32_16x16x32_bf16 v[184:187], v[120:123], v[40:43], v[184:187]
v_mfma_f32_16x16x32_bf16 v[188:191], v[124:127], v[40:43], v[188:191]
s_waitcnt vmcnt(4)
buffer_load_dwordx4 v5, s[36:39], s46 offen offset:3072 sc0 sc1 nt lds
v_mfma_f32_16x16x32_bf16 v[192:195], v[128:131], v[40:43], v[192:195]
v_mfma_f32_16x16x32_bf16 v[196:199], v[132:135], v[40:43], v[196:199]
v_mfma_f32_16x16x32_bf16 v[200:203], v[136:139], v[40:43], v[200:203]
v_mfma_f32_16x16x32_bf16 v[204:207], v[140:143], v[40:43], v[204:207]
s_waitcnt vmcnt(4)
s_add_u32 m0, s64, 8192
s_add_u32 s46, s45, 4194304
buffer_load_dwordx4 v2, s[36:39], s46 offen offset:0 sc0 sc1 nt lds
v_mfma_f32_16x16x32_bf16 v[208:211], v[144:147], v[40:43], v[208:211]
v_mfma_f32_16x16x32_bf16 v[212:215], v[148:151], v[40:43], v[212:215]
v_mfma_f32_16x16x32_bf16 v[216:219], v[152:155], v[40:43], v[216:219]
v_mfma_f32_16x16x32_bf16 v[220:223], v[156:159], v[40:43], v[220:223]
s_waitcnt vmcnt(4)
buffer_load_dwordx4 v3, s[36:39], s46 offen offset:1024 sc0 sc1 nt lds
s_waitcnt vmcnt(4)
buffer_load_dwordx4 v4, s[36:39], s46 offen offset:2048 sc0 sc1 nt lds
s_waitcnt vmcnt(4)
buffer_load_dwordx4 v5, s[36:39], s46 offen offset:3072 sc0 sc1 nt lds
s_waitcnt vmcnt(4)
s_add_u32 m0, s64, 12288
s_add_u32 s46, s45, 6291456
buffer_load_dwordx4 v2, s[36:39], s46 offen offset:0 sc0 sc1 nt lds
s_waitcnt vmcnt(4)
buffer_load_dwordx4 v3, s[36:39], s46 offen offset:1024 sc0 sc1 nt lds
s_waitcnt vmcnt(4)
buffer_load_dwordx4 v4, s[36:39], s46 offen offset:2048 sc0 sc1 nt lds
s_waitcnt vmcnt(4)
buffer_load_dwordx4 v5, s[36:39], s46 offen offset:3072 sc0 sc1 nt lds
v_xor_b32 v6, 0x4000, v6
v_xor_b32 v7, 0x4000, v7
v_xor_b32 v8, 0x4000, v8
v_xor_b32 v9, 0x4000, v9
v_xor_b32 v10, 0x4000, v10
v_xor_b32 v11, 0x4000, v11
v_xor_b32 v12, 0x4000, v12
v_xor_b32 v13, 0x4000, v13
v_xor_b32 v14, 0x4000, v14
v_xor_b32 v15, 0x4000, v15
v_xor_b32 v16, 0x4000, v16
v_xor_b32 v17, 0x4000, v17
s_xor_b32 s64, s64, 0x4000
s_add_u32 s66, s66, 1
s_cmp_eq_u32 s66, 16
s_cbranch_scc0 L_sw_8
v_cmp_eq_u32 vcc, 3, v21
v_mov_b32 v22, 0xff800000
s_nop 0
v_cndmask_b32 v20, v22, v56, vcc
L_sw_8:
s_add_u32 s65, s66, 1
s_cmp_lt_u32 s65, 29
s_cbranch_scc1 L_nx_9
s_mov_b32 s36, s52
s_mov_b32 s37, s53
s_mov_b32 s38, 0x10800000
s_mov_b32 s65, 29
L_nx_9:
s_and_b32 s62, s65, 15
s_mov_b32 s45, s62
s_brev_b32 s45, s45
s_lshr_b32 s45, s45, 28
s_lshl_b32 s45, s45, 17
s_lshr_b32 s62, s65, 4
s_lshl_b32 s62, s62, 28
s_add_u32 s45, s45, s62
s_add_u32 s45, s45, s44
s_cmp_lt_u32 s66, 29
s_cbranch_scc1 L_VB
v_xor_b32 v10, 0x4000, v10
v_xor_b32 v11, 0x4000, v11
v_xor_b32 v12, 0x4000, v12
v_xor_b32 v13, 0x4000, v13
v_xor_b32 v14, 0x4000, v14
v_xor_b32 v15, 0x4000, v15
v_xor_b32 v16, 0x4000, v16
v_xor_b32 v17, 0x4000, v17
v_mov_b32 v20, v56
s_mov_b32 s40, s54
s_mov_b32 s41, s55
s_mov_b32 s42, 0x10800000
s_add_u32 s62, s31, 64
s_lshl_b32 s62, s62, 8
s_add_u32 s62, s62, 1310720
v_mov_b32 v53, s62
v_mov_b32 v54, 1
L_dyn:
s_mov_b64 exec, 1
global_atomic_add v52, v53, v54, s[28:29] sc0 sc1
s_mov_b64 exec, -1
s_waitcnt vmcnt(7)
s_add_u32 m0, s47, 16384
s_add_u32 s46, s45, 0
buffer_load_dwordx4 v2, s[40:43], s46 offen offset:0 sc0 sc1 nt lds
ds_read_b128 v[96:99], v6 offset:0
ds_read_b128 v[100:103], v7 offset:0
ds_read_b128 v[104:107], v8 offset:0
ds_read_b128 v[108:111], v9 offset:0
ds_read_b128 v[112:115], v6 offset:256
ds_read_b128 v[116:119], v7 offset:256
ds_read_b128 v[120:123], v8 offset:256
ds_read_b128 v[124:127], v9 offset:256
s_waitcnt vmcnt(7)
buffer_load_dwordx4 v3, s[40:43], s46 offen offset:1024 sc0 sc1 nt lds
s_waitcnt lgkmcnt(0)
v_mfma_f32_16x16x32_bf16 v[32:35], v[96:99], v[64:67], v[28:31]
v_mfma_f32_16x16x32_bf16 v[32:35], v[100:103], v[68:71], v[32:35]
v_mfma_f32_16x16x32_bf16 v[32:35], v[104:107], v[72:75], v[32:35]
v_mfma_f32_16x16x32_bf16 v[32:35], v[108:111], v[76:79], v[32:35]
v_mfma_f32_16x16x32_bf16 v[32:35], v[112:115], v[80:83], v[32:35]
v_mfma_f32_16x16x32_bf16 v[32:35], v[116:119], v[84:87], v[32:35]
v_mfma_f32_16x16x32_bf16 v[32:35], v[120:123], v[88:91], v[32:35]
v_mfma_f32_16x16x32_bf16 v[32:35], v[124:127], v[92:95], v[32:35]
s_waitcnt vmcnt(7)
buffer_load_dwordx4 v4, s[40:43], s46 offen offset:2048 sc0 sc1 nt lds
s_waitcnt vmcnt(7)
buffer_load_dwordx4 v5, s[40:43], s46 offen offset:3072 sc0 sc1 nt lds
s_waitcnt vmcnt(7)
s_add_u32 m0, s47, 20480
s_add_u32 s46, s45, 2097152
buffer_load_dwordx4 v2, s[40:43], s46 offen offset:0 sc0 sc1 nt lds
s_waitcnt vmcnt(7)
buffer_load_dwordx4 v3, s[40:43], s46 offen offset:1024 sc0 sc1 nt lds
s_waitcnt vmcnt(7)
buffer_load_dwordx4 v4, s[40:43], s46 offen offset:2048 sc0 sc1 nt lds
ds_read_b128 v[128:131], v6 offset:8192
ds_read_b128 v[132:135], v7 offset:8192
ds_read_b128 v[136:139], v8 offset:8192
ds_read_b128 v[140:143], v9 offset:8192
ds_read_b128 v[144:147], v6 offset:8448
ds_read_b128 v[148:151], v7 offset:8448
ds_read_b128 v[152:155], v8 offset:8448
ds_read_b128 v[156:159], v9 offset:8448
s_waitcnt vmcnt(6)
buffer_load_dwordx4 v5, s[40:43], s46 offen offset:3072 sc0 sc1 nt lds
s_waitcnt lgkmcnt(0)
v_mfma_f32_16x16x32_bf16 v[36:39], v[128:131], v[64:67], v[28:31]
v_mfma_f32_16x16x32_bf16 v[36:39], v[132:135], v[68:71], v[36:39]
v_mfma_f32_16x16x32_bf16 v[36:39], v[136:139], v[72:75], v[36:39]
v_mfma_f32_16x16x32_bf16 v[36:39], v[140:143], v[76:79], v[36:39]
v_mfma_f32_16x16x32_bf16 v[36:39], v[144:147], v[80:83], v[36:39]
v_mfma_f32_16x16x32_bf16 v[36:39], v[148:151], v[84:87], v[36:39]
v_mfma_f32_16x16x32_bf16 v[36:39], v[152:155], v[88:91], v[36:39]
v_mfma_f32_16x16x32_bf16 v[36:39], v[156:159], v[92:95], v[36:39]
s_waitcnt vmcnt(6)
s_add_u32 m0, s47, 24576
s_add_u32 s46, s45, 4194304
buffer_load_dwordx4 v2, s[40:43], s46 offen offset:0 sc0 sc1 nt lds
s_nop 7
v_max3_f32 v22, v32, v33, v34
v_max3_f32 v23, v35, v36, v37
v_max3_f32 v22, v22, v38, v39
v_max_f32 v22, v22, v23
v_cmp_gt_f32 vcc, v22, v18
s_cbranch_vccnz L_rare_11
L_back_12:
s_waitcnt vmcnt(6)
buffer_load_dwordx4 v3, s[40:43], s46 offen offset:1024 sc0 sc1 nt lds
v_fma_f32 v44, v32, s60, v20
v_fma_f32 v45, v33, s60, v20
v_fma_f32 v46, v34, s60, v20
v_fma_f32 v47, v35, s60, v20
v_exp_f32 v44, v44
v_exp_f32 v45, v45
v_exp_f32 v46, v46
v_exp_f32 v47, v47
s_waitcnt vmcnt(6)
buffer_load_dwordx4 v4, s[40:43], s46 offen offset:2048 sc0 sc1 nt lds
v_fma_f32 v48, v36, s60, v20
v_fma_f32 v49, v37, s60, v20
v_fma_f32 v50, v38, s60, v20
v_fma_f32 v51, v39, s60, v20
v_exp_f32 v48, v48
v_exp_f32 v49, v49
v_exp_f32 v50, v50
v_exp_f32 v51, v51
s_waitcnt vmcnt(6)
buffer_load_dwordx4 v5, s[40:43], s46 offen offset:3072 sc0 sc1 nt lds
s_nop 0
v_cvt_pk_bf16_f32 v40, v44, v45
v_cvt_pk_bf16_f32 v41, v46, v47
v_cvt_pk_bf16_f32 v42, v48, v49
v_cvt_pk_bf16_f32 v43, v50, v51
v_add_f32 v22, v44, v45
v_add_f32 v23, v46, v47
v_add_f32 v24, v48, v49
v_add_f32 v25, v50, v51
v_add_f32 v22, v22, v23
v_add_f32 v24, v24, v25
v_add_f32 v22, v22, v24
v_add_f32 v19, v19, v22
s_waitcnt vmcnt(6)
s_add_u32 m0, s47, 28672
s_add_u32 s46, s45, 6291456
buffer_load_dwordx4 v2, s[40:43], s46 offen offset:0 sc0 sc1 nt lds
s_waitcnt vmcnt(6)
buffer_load_dwordx4 v3, s[40:43], s46 offen offset:1024 sc0 sc1 nt lds
s_waitcnt vmcnt(6)
buffer_load_dwordx4 v4, s[40:43], s46 offen offset:2048 sc0 sc1 nt lds
s_waitcnt vmcnt(6)
buffer_load_dwordx4 v5, s[40:43], s46 offen offset:3072 sc0 sc1 nt lds
v_readfirstlane_b32 s62, v52
s_nop 3
s_cmp_ge_u32 s62, 64
s_cselect_b32 s38, 0, 0x10800000
s_cselect_b32 s42, 0, 0x10800000
s_cselect_b32 s65, 1, 0
s_lshr_b32 s63, s62, 5
s_add_u32 s63, s63, 14
s_and_b32 s63, s63, 15
s_mov_b32 s45, s63
s_brev_b32 s45, s45
s_lshr_b32 s45, s45, 28
s_lshl_b32 s45, s45, 17
s_and_b32 s63, s62, 3
s_lshl_b32 s63, s63, 12
s_add_u32 s45, s45, s63
s_lshr_b32 s63, s62, 2
s_and_b32 s63, s63, 7
s_lshl_b32 s63, s63, 14
s_add_u32 s45, s45, s63
s_add_u32 s45, s45, 0x10000000
s_cmp_eq_u32 s65, 0
s_cbranch_scc0 L_last
s_waitcnt vmcnt(6)
s_add_u32 m0, s47, 0
s_add_u32 s46, s45, 0
buffer_load_dwordx4 v2, s[36:39], s46 offen offset:0 sc0 sc1 nt lds
ds_read_b64_tr_b16 v[96:97], v10 offset:0
ds_read_b64_tr_b16 v[100:101], v11 offset:0
ds_read_b64_tr_b16 v[104:105], v12 offset:0
ds_read_b64_tr_b16 v[108:109], v13 offset:0
ds_read_b64_tr_b16 v[112:113], v14 offset:0
ds_read_b64_tr_b16 v[116:117], v15 offset:0
ds_read_b64_tr_b16 v[120:121], v16 offset:0
ds_read_b64_tr_b16 v[124:125], v17 offset:0
ds_read_b64_tr_b16 v[128:129], v10 offset:256
ds_read_b64_tr_b16 v[132:133], v11 offset:256
ds_read_b64_tr_b16 v[136:137], v12 offset:256
ds_read_b64_tr_b16 v[140:141], v13 offset:256
ds_read_b64_tr_b16 v[144:145], v14 offset:256
ds_read_b64_tr_b16 v[148:149], v15 offset:256
ds_read_b64_tr_b16 v[152:153], v16 offset:256
ds_read_b64_tr_b16 v[156:157], v17 offset:256
s_waitcnt vmcnt(6)
buffer_load_dwordx4 v3, s[36:39], s46 offen offset:1024 sc0 sc1 nt lds
s_waitcnt vmcnt(6)
buffer_load_dwordx4 v4, s[36:39], s46 offen offset:2048 sc0 sc1 nt lds
s_waitcnt vmcnt(6)
buffer_load_dwordx4 v5, s[36:39], s46 offen offset:3072 sc0 sc1 nt lds
s_waitcnt vmcnt(6)
s_add_u32 m0, s47, 4096
s_add_u32 s46, s45, 2097152
buffer_load_dwordx4 v2, s[36:39], s46 offen offset:0 sc0 sc1 nt lds
s_waitcnt vmcnt(6)
buffer_load_dwordx4 v3, s[36:39], s46 offen offset:1024 sc0 sc1 nt lds
s_waitcnt vmcnt(6)
buffer_load_dwordx4 v4, s[36:39], s46 offen offset:2048 sc0 sc1 nt lds
ds_read_b64_tr_b16 v[98:99], v10 offset:8192
ds_read_b64_tr_b16 v[102:103], v11 offset:8192
ds_read_b64_tr_b16 v[106:107], v12 offset:8192
ds_read_b64_tr_b16 v[110:111], v13 offset:8192
ds_read_b64_tr_b16 v[114:115], v14 offset:8192
ds_read_b64_tr_b16 v[118:119], v15 offset:8192
ds_read_b64_tr_b16 v[122:123], v16 offset:8192
ds_read_b64_tr_b16 v[126:127], v17 offset:8192
ds_read_b64_tr_b16 v[130:131], v10 offset:8448
ds_read_b64_tr_b16 v[134:135], v11 offset:8448
ds_read_b64_tr_b16 v[138:139], v12 offset:8448
ds_read_b64_tr_b16 v[142:143], v13 offset:8448
ds_read_b64_tr_b16 v[146:147], v14 offset:8448
ds_read_b64_tr_b16 v[150:151], v15 offset:8448
ds_read_b64_tr_b16 v[154:155], v16 offset:8448
ds_read_b64_tr_b16 v[158:159], v17 offset:8448
s_waitcnt vmcnt(6)
buffer_load_dwordx4 v5, s[36:39], s46 offen offset:3072 sc0 sc1 nt lds
s_waitcnt lgkmcnt(0)
v_mfma_f32_16x16x32_bf16 v[160:163], v[96:99], v[40:43], v[160:163]
v_mfma_f32_16x16x32_bf16 v[164:167], v[100:103], v[40:43], v[164:167]
v_mfma_f32_16x16x32_bf16 v[168:171], v[104:107], v[40:43], v[168:171]
v_mfma_f32_16x16x32_bf16 v[172:175], v[108:111], v[40:43], v[172:175]
s_waitcnt vmcnt(6)
s_add_u32 m0, s47, 8192
s_add_u32 s46, s45, 4194304
buffer_load_dwordx4 v2, s[36:39], s46 offen offset:0 sc0 sc1 nt lds
v_mfma_f32_16x16x32_bf16 v[176:179], v[112:115], v[40:43], v[176:179]
v_mfma_f32_16x16x32_bf16 v[180:183], v[116:119], v[40:43], v[180:183]
v_mfma_f32_16x16x32_bf16 v[184:187], v[120:123], v[40:43], v[184:187]
v_mfma_f32_16x16x32_bf16 v[188:191], v[124:127], v[40:43], v[188:191]
s_waitcnt vmcnt(6)
buffer_load_dwordx4 v3, s[36:39], s46 offen offset:1024 sc0 sc1 nt lds
v_mfma_f32_16x16x32_bf16 v[192:195], v[128:131], v[40:43], v[192:195]
v_mfma_f32_16x16x32_bf16 v[196:199], v[132:135], v[40:43], v[196:199]
v_mfma_f32_16x16x32_bf16 v[200:203], v[136:139], v[40:43], v[200:203]
v_mfma_f32_16x16x32_bf16 v[204:207], v[140:143], v[40:43], v[204:207]
s_waitcnt vmcnt(6)
buffer_load_dwordx4 v4, s[36:39], s46 offen offset:2048 sc0 sc1 nt lds
v_mfma_f32_16x16x32_bf16 v[208:211], v[144:147], v[40:43], v[208:211]
v_mfma_f32_16x16x32_bf16 v[212:215], v[148:151], v[40:43], v[212:215]
v_mfma_f32_16x16x32_bf16 v[216:219], v[152:155], v[40:43], v[216:219]
v_mfma_f32_16x16x32_bf16 v[220:223], v[156:159], v[40:43], v[220:223]
s_waitcnt vmcnt(6)
buffer_load_dwordx4 v5, s[36:39], s46 offen offset:3072 sc0 sc1 nt lds
s_waitcnt vmcnt(6)
s_add_u32 m0, s47, 12288
s_add_u32 s46, s45, 6291456
buffer_load_dwordx4 v2, s[36:39], s46 offen offset:0 sc0 sc1 nt lds
s_waitcnt vmcnt(6)
buffer_load_dwordx4 v3, s[36:39], s46 offen offset:1024 sc0 sc1 nt lds
s_waitcnt vmcnt(6)
buffer_load_dwordx4 v4, s[36:39], s46 offen offset:2048 sc0 sc1 nt lds
s_waitcnt vmcnt(6)
buffer_load_dwordx4 v5, s[36:39], s46 offen offset:3072 sc0 sc1 nt lds
s_branch L_dyn
L_last:
s_waitcnt vmcnt(8)
ds_read_b64_tr_b16 v[96:97], v10 offset:0
ds_read_b64_tr_b16 v[100:101], v11 offset:0
ds_read_b64_tr_b16 v[104:105], v12 offset:0
ds_read_b64_tr_b16 v[108:109], v13 offset:0
ds_read_b64_tr_b16 v[112:113], v14 offset:0
ds_read_b64_tr_b16 v[116:117], v15 offset:0
ds_read_b64_tr_b16 v[120:121], v16 offset:0
ds_read_b64_tr_b16 v[124:125], v17 offset:0
ds_read_b64_tr_b16 v[128:129], v10 offset:256
ds_read_b64_tr_b16 v[132:133], v11 offset:256
ds_read_b64_tr_b16 v[136:137], v12 offset:256
ds_read_b64_tr_b16 v[140:141], v13 offset:256
ds_read_b64_tr_b16 v[144:145], v14 offset:256
ds_read_b64_tr_b16 v[148:149], v15 offset:256
ds_read_b64_tr_b16 v[152:153], v16 offset:256
ds_read_b64_tr_b16 v[156:157], v17 offset:256
s_waitcnt vmcnt(0)
ds_read_b64_tr_b16 v[98:99], v10 offset:8192
ds_read_b64_tr_b16 v[102:103], v11 offset:8192
ds_read_b64_tr_b16 v[106:107], v12 offset:8192
ds_read_b64_tr_b16 v[110:111], v13 offset:8192
ds_read_b64_tr_b16 v[114:115], v14 offset:8192
ds_read_b64_tr_b16 v[118:119], v15 offset:8192
ds_read_b64_tr_b16 v[122:123], v16 offset:8192
ds_read_b64_tr_b16 v[126:127], v17 offset:8192
ds_read_b64_tr_b16 v[130:131], v10 offset:8448
ds_read_b64_tr_b16 v[134:135], v11 offset:8448
ds_read_b64_tr_b16 v[138:139], v12 offset:8448
ds_read_b64_tr_b16 v[142:143], v13 offset:8448
ds_read_b64_tr_b16 v[146:147], v14 offset:8448
ds_read_b64_tr_b16 v[150:151], v15 offset:8448
ds_read_b64_tr_b16 v[154:155], v16 offset:8448
ds_read_b64_tr_b16 v[158:159], v17 offset:8448
s_waitcnt lgkmcnt(0)
v_mfma_f32_16x16x32_bf16 v[160:163], v[96:99], v[40:43], v[160:163]
v_mfma_f32_16x16x32_bf16 v[164:167], v[100:103], v[40:43], v[164:167]
v_mfma_f32_16x16x32_bf16 v[168:171], v[104:107], v[40:43], v[168:171]
v_mfma_f32_16x16x32_bf16 v[172:175], v[108:111], v[40:43], v[172:175]
v_mfma_f32_16x16x32_bf16 v[176:179], v[112:115], v[40:43], v[176:179]
v_mfma_f32_16x16x32_bf16 v[180:183], v[116:119], v[40:43], v[180:183]
v_mfma_f32_16x16x32_bf16 v[184:187], v[120:123], v[40:43], v[184:187]
v_mfma_f32_16x16x32_bf16 v[188:191], v[124:127], v[40:43], v[188:191]
v_mfma_f32_16x16x32_bf16 v[192:195], v[128:131], v[40:43], v[192:195]
v_mfma_f32_16x16x32_bf16 v[196:199], v[132:135], v[40:43], v[196:199]
v_mfma_f32_16x16x32_bf16 v[200:203], v[136:139], v[40:43], v[200:203]
v_mfma_f32_16x16x32_bf16 v[204:207], v[140:143], v[40:43], v[204:207]
v_mfma_f32_16x16x32_bf16 v[208:211], v[144:147], v[40:43], v[208:211]
v_mfma_f32_16x16x32_bf16 v[212:215], v[148:151], v[40:43], v[212:215]
v_mfma_f32_16x16x32_bf16 v[216:219], v[152:155], v[40:43], v[216:219]
v_mfma_f32_16x16x32_bf16 v[220:223], v[156:159], v[40:43], v[220:223]
s_nop 7
s_waitcnt vmcnt(0)
ds_swizzle_b32 v22, v19 offset:0x401F
s_waitcnt lgkmcnt(0)
v_add_f32 v19, v19, v22
v_mov_b32 v22, v19
s_nop 1
v_permlane32_swap_b32 v19, v22
s_nop 1
v_add_f32 v19, v19, v22
v_lshrrev_b32 v23, 4, v0
v_lshlrev_b32 v22, 10, v21
v_lshl_add_u32 v22, v23, 4, v22
v_add_u32 v22, s47, v22
v_lshlrev_b32 v23, 3, v21
v_add_u32 v23, s47, v23
s_mov_b32 s62, 0x000F000F
s_mov_b32 s63, 0x000F000F
s_mov_b64 exec, s[62:63]
ds_write_b128 v22, v[160:163] offset:0
ds_write_b128 v22, v[164:167] offset:64
ds_write_b128 v22, v[168:171] offset:128
ds_write_b128 v22, v[172:175] offset:192
ds_write_b128 v22, v[176:179] offset:256
ds_write_b128 v22, v[180:183] offset:320
ds_write_b128 v22, v[184:187] offset:384
ds_write_b128 v22, v[188:191] offset:448
ds_write_b128 v22, v[192:195] offset:512
ds_write_b128 v22, v[196:199] offset:576
ds_write_b128 v22, v[200:203] offset:640
ds_write_b128 v22, v[204:207] offset:704
ds_write_b128 v22, v[208:211] offset:768
ds_write_b128 v22, v[212:215] offset:832
ds_write_b128 v22, v[216:219] offset:896
ds_write_b128 v22, v[220:223] offset:960
s_mov_b64 exec, 15
ds_write_b64 v23, v[18:19] offset:4096
s_mov_b64 exec, -1
s_waitcnt lgkmcnt(0)
s_barrier
s_lshl_b32 s62, s3, 10
v_lshlrev_b32 v22, 4, v0
v_add_u32 v22, s62, v22
s_lshl_b32 s62, s3, 3
v_mov_b32 v23, s62
ds_read_b128 v[96:99], v22 offset:0
ds_read_b128 v[100:103], v22 offset:32768
v_add_u32 v24, 0x10000, v22
ds_read_b128 v[104:107], v24 offset:0
ds_read_b128 v[108:111], v24 offset:32768
v_add_u32 v25, 0x10000, v23
ds_read_b64 v[112:113], v23 offset:4096
ds_read_b64 v[114:115], v23 offset:36864
ds_read_b64 v[116:117], v25 offset:4096
ds_read_b64 v[118:119], v25 offset:36864
s_waitcnt lgkmcnt(0)
v_max3_f32 v120, v112, v114, v116
v_max_f32 v120, v120, v118
v_sub_f32 v112, v112, v120
v_mul_f32 v112, s60, v112
v_exp_f32 v112, v112
v_sub_f32 v114, v114, v120
v_mul_f32 v114, s60, v114
v_exp_f32 v114, v114
v_sub_f32 v116, v116, v120
v_mul_f32 v116, s60, v116
v_exp_f32 v116, v116
v_sub_f32 v118, v118, v120
v_mul_f32 v118, s60, v118
v_exp_f32 v118, v118
s_nop 0
v_mul_f32 v121, v112, v113
v_fma_f32 v121, v114, v115, v121
v_fma_f32 v121, v116, v117, v121
v_fma_f32 v121, v118, v119, v121
v_mul_f32 v124, v112, v96
v_mul_f32 v125, v112, v97
v_mul_f32 v126, v112, v98
v_mul_f32 v127, v112, v99
v_fma_f32 v124, v114, v100, v124
v_fma_f32 v125, v114, v101, v125
v_fma_f32 v126, v114, v102, v126
v_fma_f32 v127, v114, v103, v127
v_fma_f32 v124, v116, v104, v124
v_fma_f32 v125, v116, v105, v125
v_fma_f32 v126, v116, v106, v126
v_fma_f32 v127, v116, v107, v127
v_fma_f32 v124, v118, v108, v124
v_fma_f32 v125, v118, v109, v125
v_fma_f32 v126, v118, v110, v126
v_fma_f32 v127, v118, v111, v127
s_lshl_b32 s62, s2, 12
s_add_u32 s62, s62, 65536
v_add_u32 v22, s62, v22
global_store_dwordx4 v22, v[124:127], s[28:29] sc1
s_lshl_b32 s62, s2, 5
s_add_u32 s62, s62, 1114112
v_add_u32 v23, s62, v23
s_mov_b64 exec, 1
global_store_dwordx2 v23, v[120:121], s[28:29] sc1
s_mov_b64 exec, -1
s_cmp_ge_u32 s31, 14
s_cselect_b32 s35, 1, 0
s_mul_i32 s36, s35, 14
s_sub_u32 s36, s31, s36
s_cmp_ge_u32 s36, 7
s_cselect_b32 s34, 1, 0
s_mul_i32 s37, s34, 7
s_sub_u32 s36, s36, s37
s_min_u32 s36, s36, 7
s_cmp_lt_u32 s31, 28
s_cselect_b32 s37, 1, 0
s_cmp_eq_u32 s37, 0
s_cbranch_scc1 L_cend
s_and_b32 s62, s3, 1
s_lshl_b32 s62, s62, 1
s_add_u32 s62, s62, s34
s_lshr_b32 s64, s3, 1
s_add_u32 s64, s64, 2
s_cmp_eq_u32 s35, 0
s_cselect_b32 s62, s3, s62
s_cselect_b32 s64, s34, s64
s_lshl_b32 s62, s62, 3
s_add_u32 s62, s62, s30
s_lshl_b32 s62, s62, 3
s_lshl_b32 s63, s62, 12
s_lshl_b32 s65, s64, 10
s_add_u32 s63, s63, s65
s_add_u32 s63, s63, 65536
v_lshlrev_b32 v57, 4, v0
v_add_u32 v57, s63, v57
v_and_b32 v58, 7, v0
v_lshlrev_b32 v58, 5, v58
s_lshl_b32 s63, s62, 5
s_lshl_b32 s65, s64, 3
s_add_u32 s63, s63, s65
s_add_u32 s63, s63, 1114112
v_add_u32 v58, s63, v58
s_mov_b32 s67, 0
L_pc_13:
global_load_dwordx2 v[24:25], v58, s[28:29] sc1
s_waitcnt vmcnt(0)
v_cmp_o_f32 vcc, v24, v25
s_add_u32 s67, s67, 1
s_cmp_eq_u64 vcc, exec
s_cbranch_scc1 L_pcd_14
s_cmp_lt_u32 s67, 1048576
s_cbranch_scc1 L_pc_13
L_pcd_14:
s_mov_b32 s67, 0
L_rt_15:
v_mov_b32 v22, v57
global_load_dwordx4 v[96:99], v22, s[28:29] sc1
v_add_u32 v22, 0x1000, v22
global_load_dwordx4 v[100:103], v22, s[28:29] sc1
v_add_u32 v22, 0x1000, v22
global_load_dwordx4 v[104:107], v22, s[28:29] sc1
v_add_u32 v22, 0x1000, v22
global_load_dwordx4 v[108:111], v22, s[28:29] sc1
v_add_u32 v22, 0x1000, v22
global_load_dwordx4 v[112:115], v22, s[28:29] sc1
v_add_u32 v22, 0x1000, v22
global_load_dwordx4 v[116:119], v22, s[28:29] sc1
v_add_u32 v22, 0x1000, v22
global_load_dwordx4 v[120:123], v22, s[28:29] sc1
v_add_u32 v22, 0x1000, v22
global_load_dwordx4 v[124:127], v22, s[28:29] sc1
s_cmp_lg_u32 s67, 0
s_cbranch_scc1 L_sc_16
v_mov_b32 v26, v24
s_nop 1
v_max_f32_dpp v26, v26, v26 row_ror:1 row_mask:0xf bank_mask:0xf
s_nop 1
v_max_f32_dpp v26, v26, v26 row_ror:2 row_mask:0xf bank_mask:0xf
s_nop 1
v_max_f32_dpp v26, v26, v26 row_ror:4 row_mask:0xf bank_mask:0xf
v_sub_f32 v24, v24, v26
v_mul_f32 v24, s60, v24
v_exp_f32 v24, v24
s_nop 0
v_mul_f32 v26, v24, v25
s_nop 1
v_add_f32_dpp v26, v26, v26 row_ror:1 row_mask:0xf bank_mask:0xf
s_nop 1
v_add_f32_dpp v26, v26, v26 row_ror:2 row_mask:0xf bank_mask:0xf
s_nop 1
v_add_f32_dpp v26, v26, v26 row_ror:4 row_mask:0xf bank_mask:0xf
v_rcp_f32 v26, v26
s_nop 0
v_mul_f32 v24, v24, v26
s_nop 0
v_readlane_b32 s70, v24, 0
v_readlane_b32 s71, v24, 1
v_readlane_b32 s72, v24, 2
v_readlane_b32 s73, v24, 3
v_readlane_b32 s74, v24, 4
v_readlane_b32 s75, v24, 5
v_readlane_b32 s76, v24, 6
v_readlane_b32 s77, v24, 7
L_sc_16:
s_waitcnt vmcnt(0)
v_mul_f32 v44, s70, v96
v_mul_f32 v45, s70, v97
v_mul_f32 v46, s70, v98
v_mul_f32 v47, s70, v99
v_fma_f32 v44, s71, v100, v44
v_fma_f32 v45, s71, v101, v45
v_fma_f32 v46, s71, v102, v46
v_fma_f32 v47, s71, v103, v47
v_fma_f32 v44, s72, v104, v44
v_fma_f32 v45, s72, v105, v45
v_fma_f32 v46, s72, v106, v46
v_fma_f32 v47, s72, v107, v47
v_fma_f32 v44, s73, v108, v44
v_fma_f32 v45, s73, v109, v45
v_fma_f32 v46, s73, v110, v46
v_fma_f32 v47, s73, v111, v47
v_fma_f32 v44, s74, v112, v44
v_fma_f32 v45, s74, v113, v45
v_fma_f32 v46, s74, v114, v46
v_fma_f32 v47, s74, v115, v47
v_fma_f32 v44, s75, v116, v44
v_fma_f32 v45, s75, v117, v45
v_fma_f32 v46, s75, v118, v46
v_fma_f32 v47, s75, v119, v47
v_fma_f32 v44, s76, v120, v44
v_fma_f32 v45, s76, v121, v45
v_fma_f32 v46, s76, v122, v46
v_fma_f32 v47, s76, v123, v47
v_fma_f32 v44, s77, v124, v44
v_fma_f32 v45, s77, v125, v45
v_fma_f32 v46, s77, v126, v46
v_fma_f32 v47, s77, v127, v47
v_cmp_o_f32 vcc, v44, v45
v_cmp_o_f32 s[62:63], v46, v47
s_add_u32 s67, s67, 1
s_and_b64 vcc, vcc, s[62:63]
s_cmp_eq_u64 vcc, exec
s_cbranch_scc1 L_rd_17
s_cmp_lt_u32 s67, 1048576
s_cbranch_scc1 L_rt_15
L_rd_17:
v_cvt_pk_bf16_f32 v40, v44, v45
v_cvt_pk_bf16_f32 v41, v46, v47
s_lshl_b32 s62, s3, 9
s_add_u32 s62, s62, 131072
v_lshlrev_b32 v22, 3, v0
v_add_u32 v22, s62, v22
ds_write_b64 v22, v[40:41]
s_waitcnt lgkmcnt(0)
s_barrier
s_endpgm
L_cend:
s_endpgm
L_rare_11:
ds_swizzle_b32 v23, v22 offset:0x401F
s_waitcnt lgkmcnt(0)
v_max_f32 v22, v22, v23
v_mov_b32 v23, v22
s_nop 1
v_permlane32_swap_b32 v22, v23
s_nop 1
v_max_f32 v22, v22, v23
v_max_f32 v22, v22, v18
v_sub_f32 v23, v18, v22
v_mul_f32 v23, s60, v23
v_exp_f32 v23, v23
v_mov_b32 v18, v22
v_mul_f32 v20, s61, v22
v_mul_f32 v19, v19, v23
v_mul_f32 v160, v160, v23
v_mul_f32 v161, v161, v23
v_mul_f32 v162, v162, v23
v_mul_f32 v163, v163, v23
v_mul_f32 v164, v164, v23
v_mul_f32 v165, v165, v23
v_mul_f32 v166, v166, v23
v_mul_f32 v167, v167, v23
v_mul_f32 v168, v168, v23
v_mul_f32 v169, v169, v23
v_mul_f32 v170, v170, v23
v_mul_f32 v171, v171, v23
v_mul_f32 v172, v172, v23
v_mul_f32 v173, v173, v23
v_mul_f32 v174, v174, v23
v_mul_f32 v175, v175, v23
v_mul_f32 v176, v176, v23
v_mul_f32 v177, v177, v23
v_mul_f32 v178, v178, v23
v_mul_f32 v179, v179, v23
v_mul_f32 v180, v180, v23
v_mul_f32 v181, v181, v23
v_mul_f32 v182, v182, v23
v_mul_f32 v183, v183, v23
v_mul_f32 v184, v184, v23
v_mul_f32 v185, v185, v23
v_mul_f32 v186, v186, v23
v_mul_f32 v187, v187, v23
v_mul_f32 v188, v188, v23
v_mul_f32 v189, v189, v23
v_mul_f32 v190, v190, v23
v_mul_f32 v191, v191, v23
v_mul_f32 v192, v192, v23
v_mul_f32 v193, v193, v23
v_mul_f32 v194, v194, v23
v_mul_f32 v195, v195, v23
v_mul_f32 v196, v196, v23
v_mul_f32 v197, v197, v23
v_mul_f32 v198, v198, v23
v_mul_f32 v199, v199, v23
v_mul_f32 v200, v200, v23
v_mul_f32 v201, v201, v23
v_mul_f32 v202, v202, v23
v_mul_f32 v203, v203, v23
v_mul_f32 v204, v204, v23
v_mul_f32 v205, v205, v23
v_mul_f32 v206, v206, v23
v_mul_f32 v207, v207, v23
v_mul_f32 v208, v208, v23
v_mul_f32 v209, v209, v23
v_mul_f32 v210, v210, v23
v_mul_f32 v211, v211, v23
v_mul_f32 v212, v212, v23
v_mul_f32 v213, v213, v23
v_mul_f32 v214, v214, v23
v_mul_f32 v215, v215, v23
v_mul_f32 v216, v216, v23
v_mul_f32 v217, v217, v23
v_mul_f32 v218, v218, v23
v_mul_f32 v219, v219, v23
v_mul_f32 v220, v220, v23
v_mul_f32 v221, v221, v23
v_mul_f32 v222, v222, v23
v_mul_f32 v223, v223, v23
s_branch L_back_12
L_service:
s_getpc_b64 s[50:51]
L_pc:
s_sub_u32 s50, s50, L_pc-concat_heads__gqa_block_cached__mha_block_cached__decode_kernel
s_subb_u32 s51, s51, 0
v_lshlrev_b32 v4, 7, v0
v_cmp_gt_u32 vcc, L_end-concat_heads__gqa_block_cached__mha_block_cached__decode_kernel, v4
s_and_saveexec_b64 s[52:53], vcc
s_cbranch_execz L_cpf_18
global_load_dword v184, v4, s[50:51]
L_cpf_18:
s_mov_b64 exec, s[52:53]
v_add_u32 v4, 0x2000, v4
v_cmp_gt_u32 vcc, L_end-concat_heads__gqa_block_cached__mha_block_cached__decode_kernel, v4
s_and_saveexec_b64 s[52:53], vcc
s_cbranch_execz L_cpf_19
global_load_dword v185, v4, s[50:51]
L_cpf_19:
s_mov_b64 exec, s[52:53]
v_add_u32 v4, 0x2000, v4
v_cmp_gt_u32 vcc, L_end-concat_heads__gqa_block_cached__mha_block_cached__decode_kernel, v4
s_and_saveexec_b64 s[52:53], vcc
s_cbranch_execz L_cpf_20
global_load_dword v186, v4, s[50:51]
L_cpf_20:
s_mov_b64 exec, s[52:53]
v_and_b32 v1, 15, v0
v_lshrrev_b32 v2, 4, v0
s_waitcnt lgkmcnt(0)
s_cmp_eq_u32 s35, 0
s_cselect_b32 s38, s4, s14
s_cselect_b32 s39, s5, s15
s_cselect_b32 s40, s10, s20
s_cselect_b32 s41, s11, s21
s_cselect_b32 s44, s12, s22
s_cselect_b32 s45, s13, s23
s_mov_b32 s42, 3670016
s_mov_b32 s43, 0x20000
s_mov_b32 s46, 3670016
s_mov_b32 s47, 0x20000
v_lshrrev_b32 v3, 2, v0
v_and_b32 v4, 3, v0
v_lshlrev_b32 v5, 13, v3
v_lshl_add_u32 v5, v4, 4, v5
s_lshl_b32 s48, s32, 10
s_lshl_b32 s49, s36, 6
s_add_u32 s48, s48, s49
s_mov_b32 m0, 131072
s_nop 0
buffer_load_dwordx4 v5, s[40:43], s48 offen sc1 nt lds
s_mov_b32 m0, 132096
s_add_u32 s48, s48, 131072
buffer_load_dwordx4 v5, s[40:43], s48 offen sc1 nt lds
s_mov_b32 m0, 133120
s_add_u32 s48, s48, 131072
buffer_load_dwordx4 v5, s[40:43], s48 offen sc1 nt lds
s_mov_b32 m0, 134144
s_add_u32 s48, s48, 131072
buffer_load_dwordx4 v5, s[40:43], s48 offen sc1 nt lds
s_mov_b32 m0, 135168
s_add_u32 s48, s48, 131072
buffer_load_dwordx4 v5, s[40:43], s48 offen sc1 nt lds
s_mov_b32 m0, 136192
s_add_u32 s48, s48, 131072
buffer_load_dwordx4 v5, s[40:43], s48 offen sc1 nt lds
s_mov_b32 m0, 137216
s_add_u32 s48, s48, 131072
buffer_load_dwordx4 v5, s[40:43], s48 offen sc1 nt lds
s_mov_b32 m0, 138240
s_add_u32 s48, s48, 131072
buffer_load_dwordx4 v5, s[40:43], s48 offen sc1 nt lds
s_mov_b32 m0, 139264
s_add_u32 s48, s48, 131072
buffer_load_dwordx4 v5, s[40:43], s48 offen sc1 nt lds
s_mov_b32 m0, 140288
s_add_u32 s48, s48, 131072
buffer_load_dwordx4 v5, s[40:43], s48 offen sc1 nt lds
s_mov_b32 m0, 141312
s_add_u32 s48, s48, 131072
buffer_load_dwordx4 v5, s[40:43], s48 offen sc1 nt lds
s_mov_b32 m0, 142336
s_add_u32 s48, s48, 131072
buffer_load_dwordx4 v5, s[40:43], s48 offen sc1 nt lds
s_mov_b32 m0, 143360
s_add_u32 s48, s48, 131072
buffer_load_dwordx4 v5, s[40:43], s48 offen sc1 nt lds
s_mov_b32 m0, 144384
s_add_u32 s48, s48, 131072
buffer_load_dwordx4 v5, s[40:43], s48 offen sc1 nt lds
s_mov_b32 m0, 145408
s_add_u32 s48, s48, 131072
buffer_load_dwordx4 v5, s[40:43], s48 offen sc1 nt lds
s_mov_b32 m0, 146432
s_add_u32 s48, s48, 131072
buffer_load_dwordx4 v5, s[40:43], s48 offen sc1 nt lds
s_mov_b32 m0, 147456
s_add_u32 s48, s48, 131072
buffer_load_dwordx4 v5, s[40:43], s48 offen sc1 nt lds
s_mov_b32 m0, 148480
s_add_u32 s48, s48, 131072
buffer_load_dwordx4 v5, s[40:43], s48 offen sc1 nt lds
s_mov_b32 m0, 149504
s_add_u32 s48, s48, 131072
buffer_load_dwordx4 v5, s[40:43], s48 offen sc1 nt lds
s_mov_b32 m0, 150528
s_add_u32 s48, s48, 131072
buffer_load_dwordx4 v5, s[40:43], s48 offen sc1 nt lds
s_mov_b32 m0, 151552
s_add_u32 s48, s48, 131072
buffer_load_dwordx4 v5, s[40:43], s48 offen sc1 nt lds
s_mov_b32 m0, 152576
s_add_u32 s48, s48, 131072
buffer_load_dwordx4 v5, s[40:43], s48 offen sc1 nt lds
s_mov_b32 m0, 153600
s_add_u32 s48, s48, 131072
buffer_load_dwordx4 v5, s[40:43], s48 offen sc1 nt lds
s_mov_b32 m0, 154624
s_add_u32 s48, s48, 131072
buffer_load_dwordx4 v5, s[40:43], s48 offen sc1 nt lds
s_mov_b32 m0, 155648
s_add_u32 s48, s48, 131072
buffer_load_dwordx4 v5, s[40:43], s48 offen sc1 nt lds
s_mov_b32 m0, 156672
s_add_u32 s48, s48, 131072
buffer_load_dwordx4 v5, s[40:43], s48 offen sc1 nt lds
s_mov_b32 m0, 157696
s_add_u32 s48, s48, 131072
buffer_load_dwordx4 v5, s[40:43], s48 offen sc1 nt lds
s_mov_b32 m0, 158720
s_add_u32 s48, s48, 131072
buffer_load_dwordx4 v5, s[40:43], s48 offen sc1 nt lds
v_and_b32 v6, 3, v0
v_mul_u32_u24 v6, 896, v6
v_lshl_add_u32 v6, v2, 4, v6
global_load_dwordx4 v[8:11], v6, s[38:39] offset:0
global_load_dwordx4 v[12:15], v6, s[38:39] offset:64
global_load_dwordx4 v[16:19], v6, s[38:39] offset:128
global_load_dwordx4 v[20:23], v6, s[38:39] offset:192
global_load_dwordx4 v[24:27], v6, s[38:39] offset:256
global_load_dwordx4 v[28:31], v6, s[38:39] offset:320
global_load_dwordx4 v[32:35], v6, s[38:39] offset:384
global_load_dwordx4 v[36:39], v6, s[38:39] offset:448
global_load_dwordx4 v[40:43], v6, s[38:39] offset:512
global_load_dwordx4 v[44:47], v6, s[38:39] offset:576
global_load_dwordx4 v[48:51], v6, s[38:39] offset:640
global_load_dwordx4 v[52:55], v6, s[38:39] offset:704
global_load_dwordx4 v[56:59], v6, s[38:39] offset:768
global_load_dwordx4 v[60:63], v6, s[38:39] offset:832
s_cmp_eq_u32 s30, 0
s_cselect_b32 s50, 3, 2
s_mov_b32 s51, 0
s_add_u32 s52, s31, 64
s_lshl_b32 s52, s52, 8
s_add_u32 s52, s52, 1310720
v_mov_b32 v188, s52
s_lshl_b32 s52, s2, 7
s_add_u32 s52, s52, 1376256
v_writelane_b32 v188, s52, 1
v_mov_b32 v189, 0
s_mov_b64 exec, s[50:51]
global_store_dword v188, v189, s[28:29] sc1
s_mov_b64 exec, -1
L_clr_21:
v_mov_b32 v192, -1
v_mov_b32 v193, -1
v_mov_b32 v194, -1
v_mov_b32 v195, -1
s_lshl_b32 s52, s2, 12
s_add_u32 s52, s52, 65536
v_lshlrev_b32 v190, 4, v0
v_add_u32 v191, s52, v190
global_store_dwordx4 v191, v[192:195], s[28:29] offset:0 sc1
global_store_dwordx4 v191, v[192:195], s[28:29] offset:1024 sc1
global_store_dwordx4 v191, v[192:195], s[28:29] offset:2048 sc1
global_store_dwordx4 v191, v[192:195], s[28:29] offset:3072 sc1
s_lshl_b32 s52, s2, 5
s_add_u32 s52, s52, 1114112
v_add_u32 v191, s52, v190
s_mov_b64 exec, 3
global_store_dwordx4 v191, v[192:195], s[28:29] sc1
s_mov_b64 exec, -1
s_cmp_ge_u32 s31, 14
s_cselect_b32 s56, 1, 0
s_mul_i32 s58, s56, 14
s_sub_u32 s58, s31, s58
s_cmp_ge_u32 s58, 7
s_cselect_b32 s57, 1, 0
s_mul_i32 s59, s57, 7
s_sub_u32 s58, s58, s59
s_min_u32 s58, s58, 7
s_cmp_lt_u32 s31, 28
s_cselect_b32 s59, 1, 0
s_lshl_b32 s55, s30, 1
s_add_u32 s55, s55, s56
s_lshl_b32 s55, s55, 1
s_add_u32 s55, s55, s57
s_lshl_b32 s55, s55, 3
s_add_u32 s55, s55, s58
s_lshl_b32 s55, s55, 10
s_add_u32 s55, s55, 1572864
v_add_u32 v191, s55, v190
global_store_dwordx4 v191, v[192:195], s[28:29] sc1
v_lshrrev_b32 v7, 2, v1
v_lshl_add_u32 v7, v2, 3, v7
v_lshlrev_b32 v7, 6, v7
v_and_b32 v4, 3, v1
v_lshl_add_u32 v7, v4, 3, v7
v_add_u32 v7, 131072, v7
v_mov_b32 v176, 0
v_mov_b32 v177, 0
v_mov_b32 v178, 0
v_mov_b32 v179, 0
v_mov_b32 v180, 0
v_mov_b32 v181, 0
v_mov_b32 v182, 0
v_mov_b32 v183, 0
s_waitcnt vmcnt(35)
ds_read_b64_tr_b16 v[64:65], v7 offset:0
ds_read_b64_tr_b16 v[66:67], v7 offset:256
ds_read_b64_tr_b16 v[68:69], v7 offset:32
ds_read_b64_tr_b16 v[70:71], v7 offset:288
ds_read_b64_tr_b16 v[72:73], v7 offset:2048
ds_read_b64_tr_b16 v[74:75], v7 offset:2304
ds_read_b64_tr_b16 v[76:77], v7 offset:2080
ds_read_b64_tr_b16 v[78:79], v7 offset:2336
ds_read_b64_tr_b16 v[80:81], v7 offset:4096
ds_read_b64_tr_b16 v[82:83], v7 offset:4352
ds_read_b64_tr_b16 v[84:85], v7 offset:4128
ds_read_b64_tr_b16 v[86:87], v7 offset:4384
ds_read_b64_tr_b16 v[88:89], v7 offset:6144
ds_read_b64_tr_b16 v[90:91], v7 offset:6400
ds_read_b64_tr_b16 v[92:93], v7 offset:6176
ds_read_b64_tr_b16 v[94:95], v7 offset:6432
ds_read_b64_tr_b16 v[96:97], v7 offset:8192
ds_read_b64_tr_b16 v[98:99], v7 offset:8448
ds_read_b64_tr_b16 v[100:101], v7 offset:8224
ds_read_b64_tr_b16 v[102:103], v7 offset:8480
ds_read_b64_tr_b16 v[104:105], v7 offset:10240
ds_read_b64_tr_b16 v[106:107], v7 offset:10496
ds_read_b64_tr_b16 v[108:109], v7 offset:10272
ds_read_b64_tr_b16 v[110:111], v7 offset:10528
ds_read_b64_tr_b16 v[112:113], v7 offset:12288
ds_read_b64_tr_b16 v[114:115], v7 offset:12544
ds_read_b64_tr_b16 v[116:117], v7 offset:12320
ds_read_b64_tr_b16 v[118:119], v7 offset:12576
s_waitcnt vmcnt(21)
ds_read_b64_tr_b16 v[120:121], v7 offset:14336
ds_read_b64_tr_b16 v[122:123], v7 offset:14592
ds_read_b64_tr_b16 v[124:125], v7 offset:14368
ds_read_b64_tr_b16 v[126:127], v7 offset:14624
ds_read_b64_tr_b16 v[128:129], v7 offset:16384
ds_read_b64_tr_b16 v[130:131], v7 offset:16640
ds_read_b64_tr_b16 v[132:133], v7 offset:16416
ds_read_b64_tr_b16 v[134:135], v7 offset:16672
ds_read_b64_tr_b16 v[136:137], v7 offset:18432
ds_read_b64_tr_b16 v[138:139], v7 offset:18688
ds_read_b64_tr_b16 v[140:141], v7 offset:18464
ds_read_b64_tr_b16 v[142:143], v7 offset:18720
ds_read_b64_tr_b16 v[144:145], v7 offset:20480
ds_read_b64_tr_b16 v[146:147], v7 offset:20736
ds_read_b64_tr_b16 v[148:149], v7 offset:20512
ds_read_b64_tr_b16 v[150:151], v7 offset:20768
ds_read_b64_tr_b16 v[152:153], v7 offset:22528
ds_read_b64_tr_b16 v[154:155], v7 offset:22784
ds_read_b64_tr_b16 v[156:157], v7 offset:22560
ds_read_b64_tr_b16 v[158:159], v7 offset:22816
ds_read_b64_tr_b16 v[160:161], v7 offset:24576
ds_read_b64_tr_b16 v[162:163], v7 offset:24832
ds_read_b64_tr_b16 v[164:165], v7 offset:24608
ds_read_b64_tr_b16 v[166:167], v7 offset:24864
ds_read_b64_tr_b16 v[168:169], v7 offset:26624
ds_read_b64_tr_b16 v[170:171], v7 offset:26880
ds_read_b64_tr_b16 v[172:173], v7 offset:26656
ds_read_b64_tr_b16 v[174:175], v7 offset:26912
s_waitcnt vmcnt(7) lgkmcnt(0)
v_mfma_f32_16x16x32_bf16 v[176:179], v[64:67], v[8:11], v[176:179]
v_mfma_f32_16x16x32_bf16 v[180:183], v[68:71], v[8:11], v[180:183]
v_mfma_f32_16x16x32_bf16 v[176:179], v[72:75], v[12:15], v[176:179]
v_mfma_f32_16x16x32_bf16 v[180:183], v[76:79], v[12:15], v[180:183]
v_mfma_f32_16x16x32_bf16 v[176:179], v[80:83], v[16:19], v[176:179]
v_mfma_f32_16x16x32_bf16 v[180:183], v[84:87], v[16:19], v[180:183]
v_mfma_f32_16x16x32_bf16 v[176:179], v[88:91], v[20:23], v[176:179]
v_mfma_f32_16x16x32_bf16 v[180:183], v[92:95], v[20:23], v[180:183]
v_mfma_f32_16x16x32_bf16 v[176:179], v[96:99], v[24:27], v[176:179]
v_mfma_f32_16x16x32_bf16 v[180:183], v[100:103], v[24:27], v[180:183]
v_mfma_f32_16x16x32_bf16 v[176:179], v[104:107], v[28:31], v[176:179]
v_mfma_f32_16x16x32_bf16 v[180:183], v[108:111], v[28:31], v[180:183]
v_mfma_f32_16x16x32_bf16 v[176:179], v[112:115], v[32:35], v[176:179]
v_mfma_f32_16x16x32_bf16 v[180:183], v[116:119], v[32:35], v[180:183]
v_mfma_f32_16x16x32_bf16 v[176:179], v[120:123], v[36:39], v[176:179]
v_mfma_f32_16x16x32_bf16 v[180:183], v[124:127], v[36:39], v[180:183]
v_mfma_f32_16x16x32_bf16 v[176:179], v[128:131], v[40:43], v[176:179]
v_mfma_f32_16x16x32_bf16 v[180:183], v[132:135], v[40:43], v[180:183]
v_mfma_f32_16x16x32_bf16 v[176:179], v[136:139], v[44:47], v[176:179]
v_mfma_f32_16x16x32_bf16 v[180:183], v[140:143], v[44:47], v[180:183]
v_mfma_f32_16x16x32_bf16 v[176:179], v[144:147], v[48:51], v[176:179]
v_mfma_f32_16x16x32_bf16 v[180:183], v[148:151], v[48:51], v[180:183]
v_mfma_f32_16x16x32_bf16 v[176:179], v[152:155], v[52:55], v[176:179]
v_mfma_f32_16x16x32_bf16 v[180:183], v[156:159], v[52:55], v[180:183]
v_mfma_f32_16x16x32_bf16 v[176:179], v[160:163], v[56:59], v[176:179]
v_mfma_f32_16x16x32_bf16 v[180:183], v[164:167], v[56:59], v[180:183]
v_mfma_f32_16x16x32_bf16 v[176:179], v[168:171], v[60:63], v[176:179]
v_mfma_f32_16x16x32_bf16 v[180:183], v[172:175], v[60:63], v[180:183]
s_nop 7
v_cvt_pk_bf16_f32 v8, v176, v177
v_cvt_pk_bf16_f32 v9, v178, v179
v_cvt_pk_bf16_f32 v10, v180, v181
v_cvt_pk_bf16_f32 v11, v182, v183
s_lshl_b32 s48, s32, 13
s_lshl_b32 s49, s35, 10
s_add_u32 s48, s48, s49
s_lshl_b32 s49, s36, 6
s_add_u32 s48, s48, s49
v_lshlrev_b32 v4, 11, v1
v_lshl_add_u32 v4, v2, 3, v4
v_add_u32 v4, s48, v4
s_mov_b32 s62, 0x000F000F
s_mov_b32 s63, 0x000F000F
s_mov_b64 exec, s[62:63]
global_store_dwordx2 v4, v[8:9], s[28:29] sc1
global_store_dwordx2 v4, v[10:11], s[28:29] offset:32 sc1
s_mov_b64 exec, -1
s_waitcnt vmcnt(0)
s_lshl_b32 s62, s32, 5
v_mov_b32 v62, s62
v_mov_b32 v63, 1
s_mov_b64 exec, 1
global_atomic_add v61, v62, v63, s[26:27] sc0 sc1
s_mov_b64 exec, -1
s_waitcnt vmcnt(0)
v_readfirstlane_b32 s62, v61
s_nop 3
s_and_b32 s62, s62, 31
s_cmp_eq_u32 s62, 31
s_cbranch_scc0 L_rel_22
v_lshrrev_b32 v4, 3, v0
v_lshlrev_b32 v4, 3, v4
v_add_u32 v4, s32, v4
v_lshlrev_b32 v4, 3, v4
v_and_b32 v5, 7, v0
v_or_b32 v4, v4, v5
v_lshlrev_b32 v4, 7, v4
v_add_u32 v4, 1376256, v4
v_mov_b32 v5, 1
s_mov_b32 s62, -1
s_mov_b32 s63, 0
s_mov_b64 exec, s[62:63]
global_store_dword v4, v5, s[28:29] sc1
s_mov_b64 exec, -1
L_rel_22:
s_lshl_b32 s62, s2, 7
s_add_u32 s62, s62, 1376256
v_mov_b32 v4, s62
s_mov_b32 s67, 0
L_pq_23:
global_load_dword v5, v4, s[28:29] sc1
s_waitcnt vmcnt(0)
v_cmp_eq_u32 vcc, 1, v5
s_add_u32 s67, s67, 1
s_cmp_eq_u64 vcc, exec
s_cbranch_scc1 L_pqd_24
s_cmp_lt_u32 s67, 1048576
s_cbranch_scc1 L_pq_23
L_pqd_24:
s_lshl_b32 s62, s32, 2
s_add_u32 s62, s62, s33
s_lshl_b32 s62, s62, 11
v_lshlrev_b32 v4, 4, v0
v_add_u32 v5, s62, v4
global_load_dwordx4 v[8:11], v5, s[28:29] sc1
s_lshr_b32 s63, s33, 1
s_lshl_b32 s62, s32, 2
s_add_u32 s62, s62, s63
s_lshl_b32 s62, s62, 11
s_and_b32 s63, s33, 1
s_add_u32 s63, s63, 2
s_lshl_b32 s63, s63, 9
s_add_u32 s62, s62, s63
v_and_b32 v6, 31, v0
v_lshlrev_b32 v6, 4, v6
v_lshrrev_b32 v16, 5, v0
v_lshlrev_b32 v16, 12, v16
v_add_u32 v6, v6, v16
v_add_u32 v6, s62, v6
global_load_dwordx4 v[12:15], v6, s[28:29] sc1
v_add_u32 v4, 131072, v4
s_waitcnt vmcnt(0)
ds_write_b128 v4, v[8:11]
ds_write_b128 v4, v[12:15] offset:1024
s_waitcnt lgkmcnt(0)
s_barrier
s_cmp_eq_u32 s59, 0
s_cbranch_scc1 L_idle
s_cmp_eq_u32 s56, 0
s_cselect_b32 s44, s12, s22
s_cselect_b32 s45, s13, s23
v_lshrrev_b32 v3, 3, v0
v_mul_u32_u24 v5, 896, v3
v_and_b32 v4, 7, v0
v_lshl_add_u32 v5, v4, 4, v5
s_lshl_b32 s48, s30, 1
s_add_u32 s48, s48, s57
s_mul_i32 s48, s48, 229376
s_lshl_b32 s49, s58, 7
s_add_u32 s48, s48, s49
v_lshrrev_b32 v7, 2, v1
v_lshl_add_u32 v7, v2, 3, v7
v_lshlrev_b32 v7, 7, v7
v_and_b32 v4, 3, v1
v_lshl_add_u32 v7, v4, 3, v7
v_add_u32 v7, 139264, v7
s_mov_b32 m0, 139264
s_nop 0
buffer_load_dwordx4 v5, s[44:47], s48 offen nt lds
s_mov_b32 m0, 140288
s_add_u32 s48, s48, 7168
buffer_load_dwordx4 v5, s[44:47], s48 offen nt lds
s_mov_b32 m0, 141312
s_add_u32 s48, s48, 7168
buffer_load_dwordx4 v5, s[44:47], s48 offen nt lds
s_mov_b32 m0, 142336
s_add_u32 s48, s48, 7168
buffer_load_dwordx4 v5, s[44:47], s48 offen nt lds
s_mov_b32 m0, 143360
s_add_u32 s48, s48, 7168
buffer_load_dwordx4 v5, s[44:47], s48 offen nt lds
s_mov_b32 m0, 144384
s_add_u32 s48, s48, 7168
buffer_load_dwordx4 v5, s[44:47], s48 offen nt lds
s_mov_b32 m0, 145408
s_add_u32 s48, s48, 7168
buffer_load_dwordx4 v5, s[44:47], s48 offen nt lds
s_mov_b32 m0, 146432
s_add_u32 s48, s48, 7168
buffer_load_dwordx4 v5, s[44:47], s48 offen nt lds
s_waitcnt vmcnt(0)
ds_read_b64_tr_b16 v[96:97], v7 offset:0
ds_read_b64_tr_b16 v[98:99], v7 offset:512
ds_read_b64_tr_b16 v[100:101], v7 offset:32
ds_read_b64_tr_b16 v[102:103], v7 offset:544
ds_read_b64_tr_b16 v[104:105], v7 offset:64
ds_read_b64_tr_b16 v[106:107], v7 offset:576
ds_read_b64_tr_b16 v[108:109], v7 offset:96
ds_read_b64_tr_b16 v[110:111], v7 offset:608
ds_read_b64_tr_b16 v[112:113], v7 offset:4096
ds_read_b64_tr_b16 v[114:115], v7 offset:4608
ds_read_b64_tr_b16 v[116:117], v7 offset:4128
ds_read_b64_tr_b16 v[118:119], v7 offset:4640
ds_read_b64_tr_b16 v[120:121], v7 offset:4160
ds_read_b64_tr_b16 v[122:123], v7 offset:4672
ds_read_b64_tr_b16 v[124:125], v7 offset:4192
ds_read_b64_tr_b16 v[126:127], v7 offset:4704
s_waitcnt lgkmcnt(0)
s_mov_b32 m0, 139264
s_add_u32 s48, s48, 7168
buffer_load_dwordx4 v5, s[44:47], s48 offen nt lds
s_mov_b32 m0, 140288
s_add_u32 s48, s48, 7168
buffer_load_dwordx4 v5, s[44:47], s48 offen nt lds
s_mov_b32 m0, 141312
s_add_u32 s48, s48, 7168
buffer_load_dwordx4 v5, s[44:47], s48 offen nt lds
s_mov_b32 m0, 142336
s_add_u32 s48, s48, 7168
buffer_load_dwordx4 v5, s[44:47], s48 offen nt lds
s_mov_b32 m0, 143360
s_add_u32 s48, s48, 7168
buffer_load_dwordx4 v5, s[44:47], s48 offen nt lds
s_mov_b32 m0, 144384
s_add_u32 s48, s48, 7168
buffer_load_dwordx4 v5, s[44:47], s48 offen nt lds
s_mov_b32 m0, 145408
s_add_u32 s48, s48, 7168
buffer_load_dwordx4 v5, s[44:47], s48 offen nt lds
s_mov_b32 m0, 146432
s_add_u32 s48, s48, 7168
buffer_load_dwordx4 v5, s[44:47], s48 offen nt lds
s_waitcnt vmcnt(0)
ds_read_b64_tr_b16 v[128:129], v7 offset:0
ds_read_b64_tr_b16 v[130:131], v7 offset:512
ds_read_b64_tr_b16 v[132:133], v7 offset:32
ds_read_b64_tr_b16 v[134:135], v7 offset:544
ds_read_b64_tr_b16 v[136:137], v7 offset:64
ds_read_b64_tr_b16 v[138:139], v7 offset:576
ds_read_b64_tr_b16 v[140:141], v7 offset:96
ds_read_b64_tr_b16 v[142:143], v7 offset:608
ds_read_b64_tr_b16 v[144:145], v7 offset:4096
ds_read_b64_tr_b16 v[146:147], v7 offset:4608
ds_read_b64_tr_b16 v[148:149], v7 offset:4128
ds_read_b64_tr_b16 v[150:151], v7 offset:4640
ds_read_b64_tr_b16 v[152:153], v7 offset:4160
ds_read_b64_tr_b16 v[154:155], v7 offset:4672
ds_read_b64_tr_b16 v[156:157], v7 offset:4192
ds_read_b64_tr_b16 v[158:159], v7 offset:4704
s_waitcnt lgkmcnt(0)
s_mov_b32 m0, 139264
s_add_u32 s48, s48, 7168
buffer_load_dwordx4 v5, s[44:47], s48 offen nt lds
s_mov_b32 m0, 140288
s_add_u32 s48, s48, 7168
buffer_load_dwordx4 v5, s[44:47], s48 offen nt lds
s_mov_b32 m0, 141312
s_add_u32 s48, s48, 7168
buffer_load_dwordx4 v5, s[44:47], s48 offen nt lds
s_mov_b32 m0, 142336
s_add_u32 s48, s48, 7168
buffer_load_dwordx4 v5, s[44:47], s48 offen nt lds
s_mov_b32 m0, 143360
s_add_u32 s48, s48, 7168
buffer_load_dwordx4 v5, s[44:47], s48 offen nt lds
s_mov_b32 m0, 144384
s_add_u32 s48, s48, 7168
buffer_load_dwordx4 v5, s[44:47], s48 offen nt lds
s_mov_b32 m0, 145408
s_add_u32 s48, s48, 7168
buffer_load_dwordx4 v5, s[44:47], s48 offen nt lds
s_mov_b32 m0, 146432
s_add_u32 s48, s48, 7168
buffer_load_dwordx4 v5, s[44:47], s48 offen nt lds
s_waitcnt vmcnt(0)
ds_read_b64_tr_b16 v[160:161], v7 offset:0
ds_read_b64_tr_b16 v[162:163], v7 offset:512
ds_read_b64_tr_b16 v[164:165], v7 offset:32
ds_read_b64_tr_b16 v[166:167], v7 offset:544
ds_read_b64_tr_b16 v[168:169], v7 offset:64
ds_read_b64_tr_b16 v[170:171], v7 offset:576
ds_read_b64_tr_b16 v[172:173], v7 offset:96
ds_read_b64_tr_b16 v[174:175], v7 offset:608
ds_read_b64_tr_b16 v[176:177], v7 offset:4096
ds_read_b64_tr_b16 v[178:179], v7 offset:4608
ds_read_b64_tr_b16 v[180:181], v7 offset:4128
ds_read_b64_tr_b16 v[182:183], v7 offset:4640
ds_read_b64_tr_b16 v[184:185], v7 offset:4160
ds_read_b64_tr_b16 v[186:187], v7 offset:4672
ds_read_b64_tr_b16 v[188:189], v7 offset:4192
ds_read_b64_tr_b16 v[190:191], v7 offset:4704
s_waitcnt lgkmcnt(0)
s_mov_b32 m0, 139264
s_add_u32 s48, s48, 7168
buffer_load_dwordx4 v5, s[44:47], s48 offen nt lds
s_mov_b32 m0, 140288
s_add_u32 s48, s48, 7168
buffer_load_dwordx4 v5, s[44:47], s48 offen nt lds
s_mov_b32 m0, 141312
s_add_u32 s48, s48, 7168
buffer_load_dwordx4 v5, s[44:47], s48 offen nt lds
s_mov_b32 m0, 142336
s_add_u32 s48, s48, 7168
buffer_load_dwordx4 v5, s[44:47], s48 offen nt lds
s_mov_b32 m0, 143360
s_add_u32 s48, s48, 7168
buffer_load_dwordx4 v5, s[44:47], s48 offen nt lds
s_mov_b32 m0, 144384
s_add_u32 s48, s48, 7168
buffer_load_dwordx4 v5, s[44:47], s48 offen nt lds
s_mov_b32 m0, 145408
s_add_u32 s48, s48, 7168
buffer_load_dwordx4 v5, s[44:47], s48 offen nt lds
s_mov_b32 m0, 146432
s_add_u32 s48, s48, 7168
buffer_load_dwordx4 v5, s[44:47], s48 offen nt lds
s_waitcnt vmcnt(0)
ds_read_b64_tr_b16 v[192:193], v7 offset:0
ds_read_b64_tr_b16 v[194:195], v7 offset:512
ds_read_b64_tr_b16 v[196:197], v7 offset:32
ds_read_b64_tr_b16 v[198:199], v7 offset:544
ds_read_b64_tr_b16 v[200:201], v7 offset:64
ds_read_b64_tr_b16 v[202:203], v7 offset:576
ds_read_b64_tr_b16 v[204:205], v7 offset:96
ds_read_b64_tr_b16 v[206:207], v7 offset:608
ds_read_b64_tr_b16 v[208:209], v7 offset:4096
ds_read_b64_tr_b16 v[210:211], v7 offset:4608
ds_read_b64_tr_b16 v[212:213], v7 offset:4128
ds_read_b64_tr_b16 v[214:215], v7 offset:4640
ds_read_b64_tr_b16 v[216:217], v7 offset:4160
ds_read_b64_tr_b16 v[218:219], v7 offset:4672
ds_read_b64_tr_b16 v[220:221], v7 offset:4192
ds_read_b64_tr_b16 v[222:223], v7 offset:4704
s_waitcnt lgkmcnt(0)
v_lshlrev_b32 v4, 5, v0
s_mov_b64 exec, 0xff
s_mov_b32 s67, 0
L_pz_25:
global_load_dword v5, v4, s[26:27] sc1
s_waitcnt vmcnt(0)
v_cmp_le_u32 vcc, 32, v5
s_add_u32 s67, s67, 1
s_cmp_eq_u64 vcc, exec
s_cbranch_scc1 L_pzd_26
s_cmp_lt_u32 s67, 1048576
s_cbranch_scc1 L_pz_25
L_pzd_26:
s_mov_b64 exec, -1
v_and_b32 v4, 3, v0
v_lshlrev_b32 v4, 9, v4
v_lshl_add_u32 v4, v2, 4, v4
v_add_u32 v4, 131072, v4
v_mov_b32 v40, 0
v_mov_b32 v41, 0
v_mov_b32 v42, 0
v_mov_b32 v43, 0
v_mov_b32 v44, 0
v_mov_b32 v45, 0
v_mov_b32 v46, 0
v_mov_b32 v47, 0
v_mov_b32 v48, 0
v_mov_b32 v49, 0
v_mov_b32 v50, 0
v_mov_b32 v51, 0
v_mov_b32 v52, 0
v_mov_b32 v53, 0
v_mov_b32 v54, 0
v_mov_b32 v55, 0
v_lshlrev_b32 v6, 8, v1
v_lshl_add_u32 v6, v2, 4, v6
v_add_u32 v6, s55, v6
s_lshl_b32 s48, s56, 4
s_add_u32 s48, s48, s58
s_lshl_b32 s48, s48, 10
s_add_u32 s48, s48, 1572864
v_lshlrev_b32 v3, 8, v2
v_lshl_add_u32 v3, v1, 4, v3
v_add_u32 v3, s48, v3
s_mul_i32 s48, s56, 448
s_lshl_b32 s49, s58, 6
s_add_u32 s48, s48, s49
v_mul_u32_u24 v5, 896, v2
v_lshl_add_u32 v5, v1, 2, v5
v_add_u32 v5, s48, v5
v_lshlrev_b32 v5, 1, v5
s_mov_b32 s62, 0x000F000F
s_mov_b32 s63, 0x000F000F
s_barrier
s_barrier
ds_read_b128 v[8:11], v4 offset:0
ds_read_b128 v[12:15], v4 offset:64
ds_read_b128 v[16:19], v4 offset:128
ds_read_b128 v[20:23], v4 offset:192
ds_read_b128 v[24:27], v4 offset:256
ds_read_b128 v[28:31], v4 offset:320
ds_read_b128 v[32:35], v4 offset:384
ds_read_b128 v[36:39], v4 offset:448
s_waitcnt lgkmcnt(0)
v_mfma_f32_16x16x32_bf16 v[40:43], v[96:99], v[8:11], v[40:43]
v_mfma_f32_16x16x32_bf16 v[44:47], v[100:103], v[8:11], v[44:47]
v_mfma_f32_16x16x32_bf16 v[48:51], v[104:107], v[8:11], v[48:51]
v_mfma_f32_16x16x32_bf16 v[52:55], v[108:111], v[8:11], v[52:55]
v_mfma_f32_16x16x32_bf16 v[40:43], v[112:115], v[12:15], v[40:43]
v_mfma_f32_16x16x32_bf16 v[44:47], v[116:119], v[12:15], v[44:47]
v_mfma_f32_16x16x32_bf16 v[48:51], v[120:123], v[12:15], v[48:51]
v_mfma_f32_16x16x32_bf16 v[52:55], v[124:127], v[12:15], v[52:55]
v_mfma_f32_16x16x32_bf16 v[40:43], v[128:131], v[16:19], v[40:43]
v_mfma_f32_16x16x32_bf16 v[44:47], v[132:135], v[16:19], v[44:47]
v_mfma_f32_16x16x32_bf16 v[48:51], v[136:139], v[16:19], v[48:51]
v_mfma_f32_16x16x32_bf16 v[52:55], v[140:143], v[16:19], v[52:55]
v_mfma_f32_16x16x32_bf16 v[40:43], v[144:147], v[20:23], v[40:43]
v_mfma_f32_16x16x32_bf16 v[44:47], v[148:151], v[20:23], v[44:47]
v_mfma_f32_16x16x32_bf16 v[48:51], v[152:155], v[20:23], v[48:51]
v_mfma_f32_16x16x32_bf16 v[52:55], v[156:159], v[20:23], v[52:55]
v_mfma_f32_16x16x32_bf16 v[40:43], v[160:163], v[24:27], v[40:43]
v_mfma_f32_16x16x32_bf16 v[44:47], v[164:167], v[24:27], v[44:47]
v_mfma_f32_16x16x32_bf16 v[48:51], v[168:171], v[24:27], v[48:51]
v_mfma_f32_16x16x32_bf16 v[52:55], v[172:175], v[24:27], v[52:55]
v_mfma_f32_16x16x32_bf16 v[40:43], v[176:179], v[28:31], v[40:43]
v_mfma_f32_16x16x32_bf16 v[44:47], v[180:183], v[28:31], v[44:47]
v_mfma_f32_16x16x32_bf16 v[48:51], v[184:187], v[28:31], v[48:51]
v_mfma_f32_16x16x32_bf16 v[52:55], v[188:191], v[28:31], v[52:55]
v_mfma_f32_16x16x32_bf16 v[40:43], v[192:195], v[32:35], v[40:43]
v_mfma_f32_16x16x32_bf16 v[44:47], v[196:199], v[32:35], v[44:47]
v_mfma_f32_16x16x32_bf16 v[48:51], v[200:203], v[32:35], v[48:51]
v_mfma_f32_16x16x32_bf16 v[52:55], v[204:207], v[32:35], v[52:55]
v_mfma_f32_16x16x32_bf16 v[40:43], v[208:211], v[36:39], v[40:43]
v_mfma_f32_16x16x32_bf16 v[44:47], v[212:215], v[36:39], v[44:47]
v_mfma_f32_16x16x32_bf16 v[48:51], v[216:219], v[36:39], v[48:51]
v_mfma_f32_16x16x32_bf16 v[52:55], v[220:223], v[36:39], v[52:55]
s_nop 7
s_mov_b64 exec, s[62:63]
global_store_dwordx4 v6, v[40:43], s[28:29] offset:0 sc1
global_store_dwordx4 v6, v[44:47], s[28:29] offset:64 sc1
global_store_dwordx4 v6, v[48:51], s[28:29] offset:128 sc1
global_store_dwordx4 v6, v[52:55], s[28:29] offset:192 sc1
s_mov_b64 exec, -1
s_cmp_eq_u32 s57, 0
s_cbranch_scc0 L_sdone
s_cmp_eq_u32 s58, s30
s_cbranch_scc0 L_sdone
s_mov_b32 s67, 0
L_h2_27:
v_mov_b32 v4, v3
global_load_dwordx4 v[64:67], v4, s[28:29] sc1
v_add_u32 v4, 0x2000, v4
global_load_dwordx4 v[68:71], v4, s[28:29] sc1
v_add_u32 v4, 0x6000, v4
global_load_dwordx4 v[72:75], v4, s[28:29] sc1
v_add_u32 v4, 0x2000, v4
global_load_dwordx4 v[76:79], v4, s[28:29] sc1
v_add_u32 v4, 0x6000, v4
global_load_dwordx4 v[80:83], v4, s[28:29] sc1
v_add_u32 v4, 0x2000, v4
global_load_dwordx4 v[84:87], v4, s[28:29] sc1
v_add_u32 v4, 0x6000, v4
global_load_dwordx4 v[88:91], v4, s[28:29] sc1
v_add_u32 v4, 0x2000, v4
global_load_dwordx4 v[92:95], v4, s[28:29] sc1
v_add_u32 v4, 0x6000, v4
global_load_dwordx4 v[96:99], v4, s[28:29] sc1
v_add_u32 v4, 0x2000, v4
global_load_dwordx4 v[100:103], v4, s[28:29] sc1
v_add_u32 v4, 0x6000, v4
global_load_dwordx4 v[104:107], v4, s[28:29] sc1
v_add_u32 v4, 0x2000, v4
global_load_dwordx4 v[108:111], v4, s[28:29] sc1
v_add_u32 v4, 0x6000, v4
global_load_dwordx4 v[112:115], v4, s[28:29] sc1
v_add_u32 v4, 0x2000, v4
global_load_dwordx4 v[116:119], v4, s[28:29] sc1
v_add_u32 v4, 0x6000, v4
global_load_dwordx4 v[120:123], v4, s[28:29] sc1
v_add_u32 v4, 0x2000, v4
global_load_dwordx4 v[124:127], v4, s[28:29] sc1
s_waitcnt vmcnt(0)
v_add_f32 v64, v64, v68
v_add_f32 v65, v65, v69
v_add_f32 v66, v66, v70
v_add_f32 v67, v67, v71
v_add_f32 v64, v64, v72
v_add_f32 v65, v65, v73
v_add_f32 v66, v66, v74
v_add_f32 v67, v67, v75
v_add_f32 v64, v64, v76
v_add_f32 v65, v65, v77
v_add_f32 v66, v66, v78
v_add_f32 v67, v67, v79
v_add_f32 v64, v64, v80
v_add_f32 v65, v65, v81
v_add_f32 v66, v66, v82
v_add_f32 v67, v67, v83
v_add_f32 v64, v64, v84
v_add_f32 v65, v65, v85
v_add_f32 v66, v66, v86
v_add_f32 v67, v67, v87
v_add_f32 v64, v64, v88
v_add_f32 v65, v65, v89
v_add_f32 v66, v66, v90
v_add_f32 v67, v67, v91
v_add_f32 v64, v64, v92
v_add_f32 v65, v65, v93
v_add_f32 v66, v66, v94
v_add_f32 v67, v67, v95
v_add_f32 v64, v64, v96
v_add_f32 v65, v65, v97
v_add_f32 v66, v66, v98
v_add_f32 v67, v67, v99
v_add_f32 v64, v64, v100
v_add_f32 v65, v65, v101
v_add_f32 v66, v66, v102
v_add_f32 v67, v67, v103
v_add_f32 v64, v64, v104
v_add_f32 v65, v65, v105
v_add_f32 v66, v66, v106
v_add_f32 v67, v67, v107
v_add_f32 v64, v64, v108
v_add_f32 v65, v65, v109
v_add_f32 v66, v66, v110
v_add_f32 v67, v67, v111
v_add_f32 v64, v64, v112
v_add_f32 v65, v65, v113
v_add_f32 v66, v66, v114
v_add_f32 v67, v67, v115
v_add_f32 v64, v64, v116
v_add_f32 v65, v65, v117
v_add_f32 v66, v66, v118
v_add_f32 v67, v67, v119
v_add_f32 v64, v64, v120
v_add_f32 v65, v65, v121
v_add_f32 v66, v66, v122
v_add_f32 v67, v67, v123
v_add_f32 v64, v64, v124
v_add_f32 v65, v65, v125
v_add_f32 v66, v66, v126
v_add_f32 v67, v67, v127
v_cmp_o_f32 vcc, v64, v65
v_cmp_o_f32 s[60:61], v66, v67
s_add_u32 s67, s67, 1
s_and_b64 vcc, vcc, s[60:61]
s_cmp_eq_u64 vcc, exec
s_cbranch_scc1 L_h2d_28
s_cmp_lt_u32 s67, 1048576
s_cbranch_scc1 L_h2_27
L_h2d_28:
v_cvt_pk_bf16_f32 v8, v64, v65
v_cvt_pk_bf16_f32 v9, v66, v67
global_store_dwordx2 v5, v[8:9], s[24:25]
L_sdone:
s_endpgm
L_idle:
s_barrier
s_endpgm
L_end:
s_endpgm
.section .rodata,"a"
.p2align 6
.amdhsa_kernel concat_heads__gqa_block_cached__mha_block_cached__decode_kernel
  .amdhsa_next_free_vgpr 228
  .amdhsa_next_free_sgpr 102
  .amdhsa_accum_offset 228
  .amdhsa_group_segment_fixed_size 0
  .amdhsa_kernarg_size 104
  .amdhsa_user_sgpr_count 2
  .amdhsa_user_sgpr_kernarg_segment_ptr 1
  .amdhsa_system_sgpr_workgroup_id_x 1
  .amdhsa_float_denorm_mode_32 3
.end_amdhsa_kernel
```
